```python
import torch

def _softmax(x, axis=-1):
    return torch.softmax(x, dim=axis)
def _gelu(x):
    return torch.nn.functional.gelu(x, approximate="tanh")
def _silu(x):
    return torch.nn.functional.silu(x)
def _sigmoid(x):
    return torch.sigmoid(x)
def _layernorm(x, axis=-1, eps=1e-5):
    m = x.mean(dim=axis, keepdim=True)
    v = x.var(dim=axis, keepdim=True, unbiased=False)
    return (x - m) / torch.sqrt(v + eps)
def _scatter_add(tgt, idx, src, axis=0):
    return tgt.clone().index_add_(axis, idx, src)
def _segment_sum(src, seg, n):
    out = torch.zeros((n,) + src.shape[1:], dtype=src.dtype)
    return out.index_add_(0, seg, src)
def _pad(x, pw):
    flat = tuple(v for pair in reversed(pw) for v in pair)
    return torch.nn.functional.pad(x, flat)

kernel_name = 'interleave_layers__sliding_block_cached__mixer_token_mlp__decode'

def setup_inputs():

    _w = (lambda a: (lambda t: t.to(torch.bfloat16) if t.is_floating_point() else t)(torch.as_tensor(a)))
    def _A_setup():
        B, Sq, D = 2, 1, 576
        Hq, Hkv, Sk, Dh = 32, 16, 8192, 128
        assert Hq % Hkv == 0, (Hq, Hkv)
        return {
            "x": _w((lambda *s: torch.randn(*s, dtype=torch.bfloat16) * 0.1)(B, Sq, D)),
            "k_cache": _w((lambda *s: torch.randn(*s, dtype=torch.bfloat16) * 0.8)(B, Hkv, Sk, Dh)),
            "v_cache": _w((lambda *s: torch.randn(*s, dtype=torch.bfloat16) * 3.2)(B, Hkv, Sk, Dh)),
            "wq": _w((lambda *s: torch.randn(*s, dtype=torch.bfloat16) * 0.8)(D, Hq * Dh) * (D ** -0.5)),
            "wo": _w((lambda *s: torch.randn(*s, dtype=torch.bfloat16) * 3.2)(Hq * Dh, D) * ((Hq * Dh) ** -0.5)),
        }
    _A_in = _A_setup()

    def _B_setup():
        B, S, D, F = 2, 1, 576, 4608
        return {
            "x": _w((lambda *s: torch.randn(*s, dtype=torch.bfloat16) * 0.1)(B, S, D)),
            "w1": _w((lambda *s: torch.randn(*s, dtype=torch.bfloat16) * 3.2)(S, F) * (S ** -0.5)),
            "b1": _w((lambda *s: torch.randn(*s, dtype=torch.bfloat16) * 3.2)(F) * 0.02),
            "w2": _w((lambda *s: torch.randn(*s, dtype=torch.bfloat16) * 0.8)(F, S) * (F ** -0.5)),
            "b2": _w((lambda *s: torch.randn(*s, dtype=torch.bfloat16) * 0.8)(S) * 0.02),
        }
    _B_in = _B_setup()

    return {
        "A_x": _A_in["x"],
        "A_k_cache": _A_in["k_cache"],
        "A_v_cache": _A_in["v_cache"],
        "A_wq": _A_in["wq"],
        "A_wo": _A_in["wo"],
        "B_x": _B_in["x"],
        "B_w1": _B_in["w1"],
        "B_b1": _B_in["b1"],
        "B_w2": _B_in["w2"],
        "B_b2": _B_in["b2"],
    }

def reference(A_x, A_k_cache, A_v_cache, A_wq, A_wo, B_x, B_w1, B_b1, B_w2, B_b2):
    def _A_ref(x, k_cache, v_cache, wq, wo):
        B, Sq, D = x.shape
        Hq, Dh = 32, 128
        Hkv, Sk = k_cache.shape[1], k_cache.shape[2]
        W = min(4096, max(256, Sk // 4))
        rep = Hq // Hkv
        q = (lambda x, *d: x.permute(*d))((x @ wq).reshape(B, Sq, Hq, Dh), 0, 2, 1, 3)
        k = (lambda x, n, axis: torch.repeat_interleave(x, n, dim=axis))(k_cache[:, :, Sk - W:, :], rep, axis=1)
        v = (lambda x, n, axis: torch.repeat_interleave(x, n, dim=axis))(v_cache[:, :, Sk - W:, :], rep, axis=1)
        scores = torch.einsum("bhqd,bhkd->bhqk", q, k) * (Dh ** -0.5)
        p = _softmax(scores, axis=-1)
        o = torch.einsum("bhqk,bhkd->bhqd", p, v)
        return (lambda x, *d: x.permute(*d))(o, 0, 2, 1, 3).reshape(B, Sq, Hq * Dh) @ wo

    def _B_ref(x, w1, b1, w2, b2):
        B, S, D = x.shape
        h = _layernorm(x, axis=-1)
        u = torch.einsum("bsd,sf->bdf", h, w1) + b1
        u = _gelu(u)
        y = torch.einsum("bdf,fs->bds", u, w2) + b2
        return (lambda x, *d: x.permute(*d))(y, 0, 2, 1)

    x = A_x
    x = x + _A_ref(_layernorm(x, axis=-1), A_k_cache, A_v_cache, A_wq, A_wo)
    x = x + _B_ref(_layernorm(x, axis=-1), B_w1, B_b1, B_w2, B_b2)
    x = x + _A_ref(_layernorm(x, axis=-1), A_k_cache, A_v_cache, A_wq, A_wo)
    x = x + _B_ref(_layernorm(x, axis=-1), B_w1, B_b1, B_w2, B_b2)
    return x
```

```asm
; @launch grid=(256,1,1) block=(512,1,1) lds=139264
.amdgcn_target "amdgcn-amd-amdhsa--gfx950"
.text
.globl interleave_layers__sliding_block_cached__mixer_token_mlp__decode_kernel
.p2align 8
.type interleave_layers__sliding_block_cached__mixer_token_mlp__decode_kernel,@function
interleave_layers__sliding_block_cached__mixer_token_mlp__decode_kernel:
    s_cmp_ge_u32 s2, 0x100
    s_cbranch_scc1 Lend
    s_load_dwordx16 s[4:19], s[0:1], 0
    s_load_dwordx8 s[20:27], s[0:1], 64
    s_load_dwordx2 s[28:29], s[0:1], 96
    v_lshrrev_b32 v24, 6, v0
    v_and_b32 v1, 63, v0
    v_readfirstlane_b32 s30, v24
    s_cmp_lg_u32 s30, 3
    s_cbranch_scc1 Lnopref
    s_getpc_b64 s[58:59]
Lpc:
    v_lshlrev_b32 v24, 7, v1
    v_add_u32 v25, 0x2000, v24
    v_min_u32 v25, Lcode_end-Lpc-4, v25
    global_load_dword v198, v24, s[58:59]
    global_load_dword v199, v25, s[58:59]
Lnopref:
    s_and_b32 s66, s2, 7
    s_lshr_b32 s67, s2, 3
    s_lshr_b32 s68, s67, 4
    s_lshl_b32 s31, s66, 1
    s_add_u32 s31, s31, s68
    s_bfe_u32 s32, s67, 0x10003
    s_and_b32 s33, s67, 7
    s_lshl_b32 s34, s32, 4
    s_add_u32 s34, s34, s31
    s_lshr_b32 s39, s33, 1
    v_lshlrev_b32 v28, 2, v1
    v_lshlrev_b32 v29, 1, v1
    v_mov_b32 v97, 0
    v_mov_b32 v248, 0
    v_and_b32 v24, 15, v1
    v_lshrrev_b32 v25, 4, v1
    v_and_b32 v26, 7, v1
    v_lshrrev_b32 v27, 3, v1
    v_and_b32 v249, 1, v27
    v_lshl_add_u32 v249, v249, 2, v25
    v_lshlrev_b32 v249, 4, v249
    v_lshl_add_u32 v64, v26, 8, v249
    v_lshlrev_b32 v249, 4, v24
    v_lshl_add_u32 v65, v25, 10, v249
    s_mul_i32 s40, s32, 1152
    s_lshl_b32 s41, s34, 21
    s_lshl_b32 s67, s33, 16
    s_add_u32 s41, s41, s67
    s_lshl_b32 s67, s30, 13
    s_add_u32 s41, s41, s67
    s_add_u32 s41, s41, 1576960
    s_cmp_gt_u32 s30, 3
    s_cbranch_scc1 Lrole_b
    s_mul_i32 s42, s39, 1179648
    s_lshl_b32 s67, s31, 9
    s_add_u32 s42, s42, s67
    s_and_b32 s67, s33, 1
    s_lshl_b32 s67, s67, 8
    s_add_u32 s42, s42, s67
    s_lshl_b32 s67, s30, 15
    s_add_u32 s42, s42, s67
    v_lshlrev_b32 v249, 2, v25
    v_xor_b32 v249, v249, v24
    v_lshlrev_b32 v249, 4, v249
    v_lshl_add_u32 v66, v25, 13, v249
    v_mov_b32 v249, 59648
    ds_write2_b32 v249, v248, v248 offset0:1 offset1:2
    ds_write2_b32 v249, v248, v248 offset0:3 offset1:4
    ds_write2_b32 v249, v248, v248 offset0:5 offset1:6
    ds_write_b32 v249, v248 offset:28
    v_lshlrev_b32 v170, 4, v1
    v_add_u32 v170, 28672, v170
    v_add_u32 v171, 4096, v170
    s_getreg_b32 s37, hwreg(HW_REG_XCC_ID, 0, 4)
    s_cmp_lg_u32 s30, 2
    s_cbranch_scc1 Linit_a
    v_mov_b32 v244, -1
    v_mov_b32 v245, -1
    v_mov_b32 v246, -1
    v_mov_b32 v247, -1
    s_lshl_b32 s67, s34, 13
    s_lshl_b32 s68, s33, 10
    s_add_u32 s67, s67, s68
    s_add_u32 s67, s67, 131072
    v_lshl_add_u32 v251, v1, 4, s67
    v_add_u32 v252, 262144, v251
    s_lshl_b32 s67, s33, 8
    s_lshl_b32 s68, s34, 11
    s_add_u32 s67, s67, s68
    v_lshl_add_u32 v249, v1, 4, s67
    v_cmp_le_u32 vcc, 16, v1
    s_add_u32 s66, s67, 65280
    v_lshl_add_u32 v250, v1, 4, s66
    v_cndmask_b32 v249, v249, v250, vcc
    s_lshl_b32 s67, s2, 5
    v_cmp_le_u32 vcc, 32, v1
    s_add_u32 s66, s67, 654848
    v_lshl_add_u32 v250, v1, 4, s66
    v_cndmask_b32 v249, v249, v250, vcc
    v_min_u32 v243, 7, v27
    s_mul_i32 s66, s33, 8
    v_add_u32 v243, s66, v243
    v_min_u32 v243, 62, v243
    v_mul_u32_u24 v250, 7282, v243
    v_lshrrev_b32 v250, 16, v250
    v_mul_u32_u24 v250, 35712, v250
    v_lshl_add_u32 v243, v243, 7, v250
    v_lshl_add_u32 v243, v26, 4, v243
    s_mul_i32 s66, s34, 1152
    s_add_u32 s66, s66, 663552
    v_add_u32 v243, s66, v243
    s_waitcnt lgkmcnt(0)
    global_store_dwordx4 v251, v[244:247], s[28:29] sc1
    global_store_dwordx4 v252, v[244:247], s[28:29] sc1
    global_store_dwordx4 v243, v[244:247], s[28:29] sc1
    s_mov_b32 exec_hi, 3
    global_store_dwordx4 v249, v[244:247], s[28:29] sc1
    s_mov_b32 exec_hi, -1
Linit_a:
    s_waitcnt lgkmcnt(0)
    s_add_u32 s4, s4, s40
    s_addc_u32 s5, s5, 0
    s_add_u32 s10, s10, s42
    s_addc_u32 s11, s11, 0
    global_load_short_d16_hi v97, v248, s[22:23]
    global_load_dword v84, v28, s[4:5] offset:0
    global_load_dword v85, v28, s[4:5] offset:256
    global_load_dword v86, v28, s[4:5] offset:512
    global_load_dword v87, v28, s[4:5] offset:768
    global_load_ushort v88, v29, s[4:5] offset:1024
    s_add_u32 s6, s6, s41
    s_addc_u32 s7, s7, 0
    s_add_u32 s8, s8, s41
    s_addc_u32 s9, s9, 0
    s_lshl_b32 s67, s30, 10
    s_barrier
    s_add_u32 m0, s67, 4096
    s_nop 0
    global_load_lds_dwordx4 v66, s[10:11] nt
    s_add_u32 m0, s67, 8192
    v_add_u32 v66, 0x20000, v66
    global_load_lds_dwordx4 v66, s[10:11] nt
    s_add_u32 m0, s67, 12288
    v_add_u32 v66, 0x20000, v66
    global_load_lds_dwordx4 v66, s[10:11] nt
    s_add_u32 m0, s67, 16384
    v_add_u32 v66, 0x20000, v66
    global_load_lds_dwordx4 v66, s[10:11] nt
    s_add_u32 m0, s67, 20480
    v_add_u32 v66, 0x20000, v66
    global_load_lds_dwordx4 v66, s[10:11] nt
    s_add_u32 m0, s67, 24576
    v_add_u32 v66, 0x20000, v66
    global_load_lds_dwordx4 v66, s[10:11] nt
    s_add_u32 m0, s67, 28672
    v_add_u32 v66, 0x20000, v66
    global_load_lds_dwordx4 v66, s[10:11] nt
    s_add_u32 m0, s67, 32768
    v_add_u32 v66, 0x20000, v66
    global_load_lds_dwordx4 v66, s[10:11] nt
    s_add_u32 m0, s67, 36864
    v_add_u32 v66, 0x20000, v66
    global_load_lds_dwordx4 v66, s[10:11] nt
    s_cmp_lg_u32 s30, 2
    s_cbranch_scc1 Lnoflag
    s_or_b32 s66, s37, 0x80
    s_and_b32 s67, s2, 3
    s_lshl_b32 s67, s67, 3
    s_lshl_b32 s66, s66, s67
    s_and_b32 s67, s2, 0xfc
    v_mov_b32 v249, s67
    v_mov_b32 v250, s66
    s_waitcnt vmcnt(15)
    s_mov_b64 exec, 1
    global_atomic_or v249, v250, s[26:27] sc1
    s_mov_b64 exec, -1
Lnoflag:
    s_mul_i32 s67, s30, 8704
    s_add_u32 m0, s67, 69632
    s_waitcnt vmcnt(13)
    global_load_lds_dwordx4 v170, s[6:7] offset:0 nt
    s_add_u32 m0, s67, 69696
    s_waitcnt vmcnt(13)
    global_load_lds_dwordx4 v170, s[6:7] offset:1024 nt
    s_add_u32 m0, s67, 69760
    s_waitcnt vmcnt(13)
    global_load_lds_dwordx4 v170, s[6:7] offset:2048 nt
    s_add_u32 m0, s67, 69824
    s_waitcnt vmcnt(13)
    global_load_lds_dwordx4 v170, s[6:7] offset:3072 nt
    s_add_u32 m0, s67, 73984
    s_waitcnt vmcnt(13)
    global_load_lds_dwordx4 v171, s[6:7] offset:0 nt
    s_add_u32 m0, s67, 74048
    s_waitcnt vmcnt(13)
    global_load_lds_dwordx4 v171, s[6:7] offset:1024 nt
    s_add_u32 m0, s67, 74112
    s_waitcnt vmcnt(13)
    global_load_lds_dwordx4 v171, s[6:7] offset:2048 nt
    s_add_u32 m0, s67, 74176
    s_waitcnt vmcnt(13)
    global_load_lds_dwordx4 v171, s[6:7] offset:3072 nt
    s_waitcnt vmcnt(13)
    global_load_dwordx4 v[32:35], v64, s[6:7] offset:-4096 nt
    s_waitcnt vmcnt(13)
    global_load_dwordx4 v[36:39], v64, s[6:7] offset:-2048 nt
    s_waitcnt vmcnt(13)
    global_load_dwordx4 v[40:43], v64, s[6:7] offset:-3968 nt
    s_waitcnt vmcnt(13)
    global_load_dwordx4 v[44:47], v64, s[6:7] offset:-1920 nt
    s_waitcnt vmcnt(13)
    global_load_dwordx4 v[48:51], v64, s[6:7] offset:0 nt
    s_waitcnt vmcnt(13)
    global_load_dwordx4 v[52:55], v64, s[6:7] offset:2048 nt
    s_waitcnt vmcnt(13)
    global_load_dwordx4 v[56:59], v64, s[6:7] offset:128 nt
    s_waitcnt vmcnt(13)
    global_load_dwordx4 v[60:63], v64, s[6:7] offset:2176 nt
    s_mul_i32 s66, s34, 2048
    s_add_u32 s58, s28, s66
    s_addc_u32 s59, s29, 0
    s_mul_i32 s66, s34, 8192
    s_add_u32 s66, s66, 131072
    s_add_u32 s60, s28, s66
    s_addc_u32 s61, s29, 0
    s_mul_i32 s66, s32, 18432
    s_add_u32 s66, s66, 663552
    s_add_u32 s64, s28, s66
    s_addc_u32 s65, s29, 0
    s_call_b64 s[56:57], Laddr
    v_bfe_u32 v248, v1, 2, 2
    v_xor_b32 v249, s30, v248
    v_and_b32 v250, 3, v1
    v_lshl_add_u32 v249, v249, 2, v250
    v_lshlrev_b32 v249, 4, v249
    v_lshl_add_u32 v249, v248, 8, v249
    v_add_u32 v249, 4096, v249
    v_lshrrev_b32 v250, 4, v1
    v_lshl_add_u32 v248, v250, 10, v249
    v_lshl_add_u32 v249, v250, 11, v249
    v_mov_b32 v244, 0x3f803f80
    v_mov_b32 v245, 0x3f803f80
    v_mov_b32 v246, 0x3f803f80
    v_mov_b32 v247, 0x3f803f80
    v_mov_b32 v169, v65
    v_mov_b32 v168, v64
    s_waitcnt vmcnt(16)
    v_mov_b32 v252, 59652
    v_mov_b32 v253, 1
    s_mov_b64 exec, 1
    ds_add_u32 v252, v253
    s_mov_b64 exec, -1
Lsync_a:
    ds_read_b32 v253, v252
    s_waitcnt lgkmcnt(0)
    v_readfirstlane_b32 s66, v253
    s_cmp_ge_u32 s66, 4
    s_cbranch_scc1 Lsync_a_ok
    s_sub_u32 s38, s38, 1
    s_cbranch_scc0 Lsync_a
    s_mov_b32 s38, 0
Lsync_a_ok:
    ds_read_b64_tr_b16 v[132:133], v249 offset:0
    ds_read_b64_tr_b16 v[134:135], v249 offset:1024
    ds_read_b64_tr_b16 v[136:137], v249 offset:8192
    ds_read_b64_tr_b16 v[138:139], v249 offset:9216
    ds_read_b64_tr_b16 v[140:141], v249 offset:16384
    ds_read_b64_tr_b16 v[142:143], v249 offset:17408
    ds_read_b64_tr_b16 v[144:145], v249 offset:24576
    ds_read_b64_tr_b16 v[146:147], v249 offset:25600
    ds_read_b64_tr_b16 v[148:149], v248 offset:32768
    ds_read_b64_tr_b16 v[150:151], v249 offset:8
    ds_read_b64_tr_b16 v[152:153], v249 offset:1032
    ds_read_b64_tr_b16 v[154:155], v249 offset:8200
    ds_read_b64_tr_b16 v[156:157], v249 offset:9224
    ds_read_b64_tr_b16 v[158:159], v249 offset:16392
    ds_read_b64_tr_b16 v[160:161], v249 offset:17416
    ds_read_b64_tr_b16 v[162:163], v249 offset:24584
    ds_read_b64_tr_b16 v[164:165], v249 offset:25608
    ds_read_b64_tr_b16 v[166:167], v248 offset:32776
    s_waitcnt lgkmcnt(0)
    v_mfma_f32_16x16x32_bf16 v[188:191], v[132:135], v[244:247], 0
    v_mfma_f32_16x16x32_bf16 v[192:195], v[150:153], v[244:247], 0
    v_mfma_f32_16x16x32_bf16 v[188:191], v[136:139], v[244:247], v[188:191]
    v_mfma_f32_16x16x32_bf16 v[192:195], v[154:157], v[244:247], v[192:195]
    v_mfma_f32_16x16x32_bf16 v[188:191], v[140:143], v[244:247], v[188:191]
    v_mfma_f32_16x16x32_bf16 v[192:195], v[158:161], v[244:247], v[192:195]
    v_mfma_f32_16x16x32_bf16 v[188:191], v[144:147], v[244:247], v[188:191]
    v_mfma_f32_16x16x32_bf16 v[192:195], v[162:165], v[244:247], v[192:195]
    s_nop 5
    v_mfma_f32_16x16x16_bf16 v[188:191], v[148:149], v[244:245], v[188:191]
    v_mfma_f32_16x16x16_bf16 v[192:195], v[166:167], v[244:245], v[192:195]
    s_mov_b32 s18, -1
    s_mov_b32 s50, 0x00110011
    s_mov_b32 s51, 0x00110011
    s_mov_b32 s52, 0x00010001
    s_mov_b32 s53, 0x00010001
    s_mov_b32 s54, 0x01010101
    s_mov_b32 s55, 0x01010101
    s_call_b64 s[56:57], Lqstage
    s_mov_b32 s18, 0
    v_mov_b32 v252, 59652
    v_mov_b32 v253, 1
    s_mov_b64 exec, 1
    ds_add_u32 v252, v253
    s_mov_b64 exec, -1
    s_cmp_lg_u32 s30, 0
    s_cbranch_scc1 Lnolook
    v_lshlrev_b32 v250, 2, v1
    global_load_dword v172, v250, s[26:27] sc1
Lnolook:
    s_mul_i32 s67, s30, 8704
    s_add_u32 m0, s67, 104448
    s_waitcnt vmcnt(13)
    global_load_lds_dwordx4 v170, s[8:9] offset:0 nt
    s_add_u32 m0, s67, 104512
    s_waitcnt vmcnt(13)
    global_load_lds_dwordx4 v170, s[8:9] offset:1024 nt
    s_add_u32 m0, s67, 104576
    s_waitcnt vmcnt(13)
    global_load_lds_dwordx4 v170, s[8:9] offset:2048 nt
    s_add_u32 m0, s67, 104640
    s_waitcnt vmcnt(13)
    global_load_lds_dwordx4 v170, s[8:9] offset:3072 nt
    s_add_u32 m0, s67, 108800
    s_waitcnt vmcnt(13)
    global_load_lds_dwordx4 v171, s[8:9] offset:0 nt
    s_add_u32 m0, s67, 108864
    s_waitcnt vmcnt(13)
    global_load_lds_dwordx4 v171, s[8:9] offset:1024 nt
    s_add_u32 m0, s67, 108928
    s_waitcnt vmcnt(13)
    global_load_lds_dwordx4 v171, s[8:9] offset:2048 nt
    s_add_u32 m0, s67, 108992
    s_waitcnt vmcnt(13)
    global_load_lds_dwordx4 v171, s[8:9] offset:3072 nt
    s_waitcnt vmcnt(16)
    v_mov_b32 v252, 59660
    v_mov_b32 v253, 1
    s_mov_b64 exec, 1
    ds_add_u32 v252, v253
    s_mov_b64 exec, -1
    s_call_b64 s[56:57], Lsel
    s_cmp_eq_u32 s30, 0
    s_cbranch_scc1 Lwave0
    s_waitcnt vmcnt(13)
    global_load_dwordx4 v[200:203], v169, s[8:9] offset:-4096 nt
    s_waitcnt vmcnt(13)
    global_load_dwordx4 v[204:207], v169, s[8:9] offset:-3840 nt
    s_waitcnt vmcnt(13)
    global_load_dwordx4 v[208:211], v169, s[8:9] offset:-3584 nt
    s_waitcnt vmcnt(13)
    global_load_dwordx4 v[212:215], v169, s[8:9] offset:-3328 nt
    s_waitcnt vmcnt(13)
    global_load_dwordx4 v[216:219], v169, s[8:9] offset:0 nt
    s_waitcnt vmcnt(13)
    global_load_dwordx4 v[220:223], v169, s[8:9] offset:256 nt
    s_waitcnt vmcnt(13)
    global_load_dwordx4 v[224:227], v169, s[8:9] offset:512 nt
    s_waitcnt vmcnt(13)
    global_load_dwordx4 v[228:231], v169, s[8:9] offset:768 nt
    s_cmp_lg_u32 s30, 3
    s_cbranch_scc1 Lnox0
    ds_write_b64 v19, v[234:235] offset:0
    ds_write_b64 v19, v[236:237] offset:512
    ds_write_b64 v19, v[238:239] offset:1024
    ds_write_b64 v19, v[240:241] offset:1536
    ds_write_b32 v20, v242
Lnox0:
    s_mul_i32 s66, s31, 294912
    s_mul_i32 s67, s33, 144
    s_add_u32 s66, s66, s67
    s_add_u32 s12, s12, s66
    s_addc_u32 s13, s13, 0
    s_mul_i32 s66, s30, 48
    s_sub_u32 s66, s66, 48
    v_min_u32 v248, 47, v1
    v_add_u32 v248, s66, v248
    v_mul_u32_u24 v250, 7282, v248
    v_lshrrev_b32 v250, 16, v250
    v_mul_u32_u24 v250, 9072, v250
    v_lshl_add_u32 v232, v248, 4, v250
    s_waitcnt vmcnt(16)
    s_call_b64 s[56:57], Lkshuf
    v_mov_b32 v252, 59652
Lsync_wo:
    ds_read_b32 v253, v252
    s_waitcnt lgkmcnt(0)
    v_readfirstlane_b32 s66, v253
    s_cmp_ge_u32 s66, 9
    s_cbranch_scc1 Lsync_wo_ok
    s_sub_u32 s38, s38, 1
    s_cbranch_scc0 Lsync_wo
    s_mov_b32 s38, 0
Lsync_wo_ok:
    s_mul_i32 s67, s30, 768
    s_mov_b32 exec_hi, 0xffff
    s_add_u32 m0, s67, 3328
    s_waitcnt vmcnt(11)
    global_load_lds_dwordx4 v232, s[12:13] nt
    s_add_u32 m0, s67, 5632
    s_add_u32 s12, s12, 1152
    s_addc_u32 s13, s13, 0
    s_waitcnt vmcnt(11)
    global_load_lds_dwordx4 v232, s[12:13] nt
    s_add_u32 m0, s67, 7936
    s_add_u32 s12, s12, 1152
    s_addc_u32 s13, s13, 0
    s_waitcnt vmcnt(11)
    global_load_lds_dwordx4 v232, s[12:13] nt
    s_add_u32 m0, s67, 10240
    s_add_u32 s12, s12, 1152
    s_addc_u32 s13, s13, 0
    s_waitcnt vmcnt(11)
    global_load_lds_dwordx4 v232, s[12:13] nt
    s_mov_b32 exec_hi, -1
    s_waitcnt vmcnt(12)
    s_lshl_b32 s66, 1, s30
    v_mov_b32 v252, 59672
    v_mov_b32 v253, s66
    s_mov_b64 exec, 1
    ds_or_b32 v252, v253
    s_mov_b64 exec, -1
    s_mul_i32 s67, s30, 768
    s_mov_b32 exec_hi, 0xffff
    s_add_u32 m0, s67, 12544
    s_add_u32 s12, s12, 1152
    s_addc_u32 s13, s13, 0
    s_waitcnt vmcnt(11)
    global_load_lds_dwordx4 v232, s[12:13] nt
    s_add_u32 m0, s67, 14848
    s_add_u32 s12, s12, 1152
    s_addc_u32 s13, s13, 0
    s_waitcnt vmcnt(11)
    global_load_lds_dwordx4 v232, s[12:13] nt
    s_add_u32 m0, s67, 17152
    s_add_u32 s12, s12, 1152
    s_addc_u32 s13, s13, 0
    s_waitcnt vmcnt(11)
    global_load_lds_dwordx4 v232, s[12:13] nt
    s_add_u32 m0, s67, 19456
    s_add_u32 s12, s12, 1152
    s_addc_u32 s13, s13, 0
    s_waitcnt vmcnt(11)
    global_load_lds_dwordx4 v232, s[12:13] nt
    s_add_u32 m0, s67, 21760
    s_add_u32 s12, s12, 139392
    s_addc_u32 s13, s13, 0
    s_waitcnt vmcnt(11)
    global_load_lds_dwordx4 v232, s[12:13] nt
    s_add_u32 m0, s67, 24064
    s_add_u32 s12, s12, 1152
    s_addc_u32 s13, s13, 0
    s_waitcnt vmcnt(11)
    global_load_lds_dwordx4 v232, s[12:13] nt
    s_mov_b32 exec_hi, -1
    s_branch Lmeet
Lwave0:
    s_lshr_b32 s66, s2, 6
    s_lshl_b32 s66, s66, 4
    s_bfe_u32 s67, s2, 0x10002
    s_add_u32 s66, s66, s67
    s_mov_b64 s[14:15], 0x5555
    s_lshl_b64 s[14:15], s[14:15], s66
    s_and_b32 s68, s2, 3
    s_lshl_b32 s68, s68, 3
    v_lshlrev_b32 v250, 2, v1
    s_waitcnt vmcnt(8)
    s_branch Lflagchk
Lflagpoll:
    global_load_dword v172, v250, s[26:27] sc1
    s_waitcnt vmcnt(0)
Lflagchk:
    v_bfe_u32 v251, v172, s68, 8
    v_cmp_gt_u32 vcc, 0x80, v251
    s_and_b64 vcc, vcc, s[14:15]
    s_cbranch_scc0 Lflagok
    s_sub_u32 s38, s38, 1
    s_cbranch_scc0 Lflagpoll
    s_mov_b32 s38, 0
Lflagok:
    global_load_dwordx4 v[234:237], v98, s[58:59] offset:0 sc1
    global_load_dwordx4 v[238:241], v98, s[58:59] offset:256 sc1
    global_load_dword v64, v250, s[26:27] sc1
    v_and_b32 v251, 15, v251
    v_cmp_ne_u32 vcc, s37, v251
    v_mov_b32 v251, 59648
    s_and_b64 vcc, vcc, s[14:15]
    s_cselect_b32 s66, 0, 1
    v_mov_b32 v253, s66
    ds_write_b32 v251, v253
    v_mov_b32 v252, 59652
    v_mov_b32 v253, 1
    s_mov_b64 exec, 1
    ds_add_u32 v252, v253
    s_mov_b64 exec, -1
    s_waitcnt vmcnt(13)
    global_load_dwordx4 v[200:203], v169, s[8:9] offset:-4096 nt
    s_waitcnt vmcnt(13)
    global_load_dwordx4 v[204:207], v169, s[8:9] offset:-3840 nt
    s_waitcnt vmcnt(13)
    global_load_dwordx4 v[208:211], v169, s[8:9] offset:-3584 nt
    s_waitcnt vmcnt(13)
    global_load_dwordx4 v[212:215], v169, s[8:9] offset:-3328 nt
    s_waitcnt vmcnt(13)
    global_load_dwordx4 v[216:219], v169, s[8:9] offset:0 nt
    s_waitcnt vmcnt(13)
    global_load_dwordx4 v[220:223], v169, s[8:9] offset:256 nt
    s_waitcnt vmcnt(13)
    global_load_dwordx4 v[224:227], v169, s[8:9] offset:512 nt
    s_waitcnt vmcnt(13)
    global_load_dwordx4 v[228:231], v169, s[8:9] offset:768 nt
    s_call_b64 s[56:57], Lkshuf
    s_waitcnt vmcnt(11)
    s_lshl_b32 s66, 1, s30
    v_mov_b32 v252, 59672
    v_mov_b32 v253, s66
    s_mov_b64 exec, 1
    ds_or_b32 v252, v253
    s_mov_b64 exec, -1
    s_waitcnt vmcnt(8)
    s_branch Lq0chk
Lq0poll:
    global_load_dwordx4 v[234:237], v98, s[58:59] offset:0 sc1
    global_load_dwordx4 v[238:241], v98, s[58:59] offset:256 sc1
    global_load_dword v64, v250, s[26:27] sc1
    s_waitcnt vmcnt(0)
Lq0chk:
    v_mfma_f32_16x16x32_bf16 v[24:27], v[196:199], v[234:237], 0
    v_mfma_f32_16x16x32_bf16 v[28:31], v[196:199], v[238:241], 0
    v_max3_u32 v255, v234, v235, v236
    v_max3_u32 v255, v255, v237, v238
    v_max3_u32 v255, v255, v239, v240
    v_max_u32 v255, v255, v241
    v_and_b32 v64, 0x80808080, v64
    v_cmp_ne_u32 vcc, 0x80808080, v64
    s_nop 1
    v_cndmask_b32 v255, v255, -1, vcc
    v_cmp_eq_u32 vcc, -1, v255
    s_cbranch_vccz Lq0poll_ok
    s_sub_u32 s38, s38, 1
    s_cbranch_scc0 Lq0poll
    s_mov_b32 s38, 0
Lq0poll_ok:
    v_cvt_pk_bf16_f32 v234, v24, v25
    v_cvt_pk_bf16_f32 v235, v26, v27
    v_cvt_pk_bf16_f32 v236, v28, v29
    v_cvt_pk_bf16_f32 v237, v30, v31
    s_mov_b32 exec_hi, 0
    ds_write_b64 v99, v[234:235] offset:0
    ds_write_b64 v99, v[236:237] offset:256
    s_mov_b32 exec_hi, -1
    s_branch Lmeet
Lrole_b:
    v_subrev_u32 v31, 0x100, v0
    v_lshlrev_b32 v30, 4, v31
    v_add_u32 v249, 0x1000, v30
    v_lshlrev_b32 v31, 2, v31
    v_add_u32 v31, 0x2000, v31
    s_waitcnt lgkmcnt(0)
    global_load_dwordx4 v[132:135], v30, s[16:17]
    global_load_dwordx4 v[136:139], v249, s[16:17]
    global_load_dword v140, v31, s[16:17]
    global_load_dwordx4 v[142:145], v30, s[18:19]
    global_load_dwordx4 v[146:149], v249, s[18:19]
    global_load_dword v150, v31, s[18:19]
    global_load_dwordx4 v[152:155], v30, s[20:21]
    global_load_dwordx4 v[156:159], v249, s[20:21]
    global_load_dword v160, v31, s[20:21]
    global_load_short_d16_hi v97, v248, s[22:23]
    s_barrier
    s_mul_i32 s66, s34, 2048
    s_add_u32 s58, s28, s66
    s_addc_u32 s59, s29, 0
    s_mul_i32 s66, s34, 8192
    s_add_u32 s66, s66, 131072
    s_add_u32 s60, s28, s66
    s_addc_u32 s61, s29, 0
    s_mul_i32 s66, s32, 18432
    s_add_u32 s66, s66, 663552
    s_add_u32 s64, s28, s66
    s_addc_u32 s65, s29, 0
    s_call_b64 s[56:57], Laddr
    s_and_b32 s66, s2, 127
    s_lshl_b32 s66, s66, 4
    s_add_u32 s66, s66, 14592
    s_lshr_b32 s67, s2, 7
    s_lshl_b32 s67, s67, 15
    s_add_u32 s66, s66, s67
    v_add_u32 v249, s66, v1
    v_lshlrev_b32 v249, 16, v249
    v_mul_f32 v249, 0x3eeff558, v249
    v_mov_b32 v250, 0x409d30fc
    v_mov_b32 v38, 1.0
    v_mov_b32 v40, 0xc2700000
    v_mov_b32 v252, 0x3eeff558
    v_readlane_b32 s40, v249, 0
    v_mov_b32 v168, 0
    v_readlane_b32 s41, v249, 1
    v_mov_b32 v169, 0
    v_readlane_b32 s42, v249, 2
    v_mov_b32 v170, 0
    v_readlane_b32 s43, v249, 3
    v_mov_b32 v171, 0
    v_readlane_b32 s44, v249, 4
    v_mov_b32 v172, 0
    v_readlane_b32 s45, v249, 5
    v_mov_b32 v173, 0
    v_readlane_b32 s46, v249, 6
    v_mov_b32 v174, 0
    v_readlane_b32 s47, v249, 7
    v_mov_b32 v175, 0
    v_readlane_b32 s48, v249, 8
    v_mov_b32 v176, 0
    v_readlane_b32 s49, v249, 9
    v_mov_b32 v177, 0
    v_readlane_b32 s50, v249, 10
    v_mov_b32 v178, 0
    v_readlane_b32 s51, v249, 11
    v_mov_b32 v179, 0
    v_readlane_b32 s52, v249, 12
    v_mov_b32 v180, 0
    v_readlane_b32 s53, v249, 13
    v_mov_b32 v181, 0
    v_readlane_b32 s54, v249, 14
    v_mov_b32 v182, 0
    v_readlane_b32 s55, v249, 15
    v_mov_b32 v183, 0
    s_mov_b32 s3, 0
    s_waitcnt vmcnt(0)
Ltabloop:
    s_set_gpr_idx_on s3, gpr_idx(SRC1)
    v_lshlrev_b32 v162, 16, v132
    v_and_b32 v32, 0xffff0000, v132
    v_lshlrev_b32 v164, 16, v142
    v_and_b32 v34, 0xffff0000, v142
    v_lshlrev_b32 v166, 16, v152
    v_and_b32 v36, 0xffff0000, v152
    s_set_gpr_idx_off
    v_mul_f32 v164, v164, v252
    v_mul_f32 v34, v34, v252
    v_pk_fma_f32 v[184:185], v[162:163], s[40:41], v[164:165] op_sel_hi:[0,1,0]
    v_pk_fma_f32 v[192:193], v[162:163], s[42:43], v[164:165] op_sel_hi:[0,1,0]
    v_pk_fma_f32 v[186:187], v[184:185], v[184:185], v[250:251] op_sel_hi:[1,1,0]
    v_pk_fma_f32 v[194:195], v[192:193], v[192:193], v[250:251] op_sel_hi:[1,1,0]
    v_pk_mul_f32 v[186:187], v[186:187], v[184:185] neg_lo:[1,0] neg_hi:[1,0]
    v_pk_mul_f32 v[194:195], v[194:195], v[192:193] neg_lo:[1,0] neg_hi:[1,0]
    v_exp_f32 v188, v186
    v_exp_f32 v189, v187
    v_exp_f32 v196, v194
    v_exp_f32 v197, v195
    v_pk_mul_f32 v[190:191], v[184:185], v[166:167] op_sel_hi:[1,0]
    v_pk_add_f32 v[188:189], v[188:189], v[38:39] op_sel_hi:[1,0]
    v_pk_mul_f32 v[198:199], v[192:193], v[166:167] op_sel_hi:[1,0]
    v_pk_add_f32 v[196:197], v[196:197], v[38:39] op_sel_hi:[1,0]
    v_rcp_f32 v188, v188
    v_rcp_f32 v189, v189
    v_rcp_f32 v196, v196
    v_rcp_f32 v197, v197
    v_pk_fma_f32 v[168:169], v[190:191], v[188:189], v[168:169]
    v_pk_fma_f32 v[170:171], v[198:199], v[196:197], v[170:171]
    v_pk_fma_f32 v[184:185], v[162:163], s[44:45], v[164:165] op_sel_hi:[0,1,0]
    v_pk_fma_f32 v[192:193], v[162:163], s[46:47], v[164:165] op_sel_hi:[0,1,0]
    v_pk_fma_f32 v[186:187], v[184:185], v[184:185], v[250:251] op_sel_hi:[1,1,0]
    v_pk_fma_f32 v[194:195], v[192:193], v[192:193], v[250:251] op_sel_hi:[1,1,0]
    v_pk_mul_f32 v[186:187], v[186:187], v[184:185] neg_lo:[1,0] neg_hi:[1,0]
    v_pk_mul_f32 v[194:195], v[194:195], v[192:193] neg_lo:[1,0] neg_hi:[1,0]
    v_exp_f32 v188, v186
    v_exp_f32 v189, v187
    v_exp_f32 v196, v194
    v_exp_f32 v197, v195
    v_pk_mul_f32 v[190:191], v[184:185], v[166:167] op_sel_hi:[1,0]
    v_pk_add_f32 v[188:189], v[188:189], v[38:39] op_sel_hi:[1,0]
    v_pk_mul_f32 v[198:199], v[192:193], v[166:167] op_sel_hi:[1,0]
    v_pk_add_f32 v[196:197], v[196:197], v[38:39] op_sel_hi:[1,0]
    v_rcp_f32 v188, v188
    v_rcp_f32 v189, v189
    v_rcp_f32 v196, v196
    v_rcp_f32 v197, v197
    v_pk_fma_f32 v[172:173], v[190:191], v[188:189], v[172:173]
    v_pk_fma_f32 v[174:175], v[198:199], v[196:197], v[174:175]
    v_pk_fma_f32 v[184:185], v[162:163], s[48:49], v[164:165] op_sel_hi:[0,1,0]
    v_pk_fma_f32 v[192:193], v[162:163], s[50:51], v[164:165] op_sel_hi:[0,1,0]
    v_pk_fma_f32 v[186:187], v[184:185], v[184:185], v[250:251] op_sel_hi:[1,1,0]
    v_pk_fma_f32 v[194:195], v[192:193], v[192:193], v[250:251] op_sel_hi:[1,1,0]
    v_pk_mul_f32 v[186:187], v[186:187], v[184:185] neg_lo:[1,0] neg_hi:[1,0]
    v_pk_mul_f32 v[194:195], v[194:195], v[192:193] neg_lo:[1,0] neg_hi:[1,0]
    v_exp_f32 v188, v186
    v_exp_f32 v189, v187
    v_exp_f32 v196, v194
    v_exp_f32 v197, v195
    v_pk_mul_f32 v[190:191], v[184:185], v[166:167] op_sel_hi:[1,0]
    v_pk_add_f32 v[188:189], v[188:189], v[38:39] op_sel_hi:[1,0]
    v_pk_mul_f32 v[198:199], v[192:193], v[166:167] op_sel_hi:[1,0]
    v_pk_add_f32 v[196:197], v[196:197], v[38:39] op_sel_hi:[1,0]
    v_rcp_f32 v188, v188
    v_rcp_f32 v189, v189
    v_rcp_f32 v196, v196
    v_rcp_f32 v197, v197
    v_pk_fma_f32 v[176:177], v[190:191], v[188:189], v[176:177]
    v_pk_fma_f32 v[178:179], v[198:199], v[196:197], v[178:179]
    v_pk_fma_f32 v[184:185], v[162:163], s[52:53], v[164:165] op_sel_hi:[0,1,0]
    v_pk_fma_f32 v[192:193], v[162:163], s[54:55], v[164:165] op_sel_hi:[0,1,0]
    v_pk_fma_f32 v[186:187], v[184:185], v[184:185], v[250:251] op_sel_hi:[1,1,0]
    v_pk_fma_f32 v[194:195], v[192:193], v[192:193], v[250:251] op_sel_hi:[1,1,0]
    v_pk_mul_f32 v[186:187], v[186:187], v[184:185] neg_lo:[1,0] neg_hi:[1,0]
    v_pk_mul_f32 v[194:195], v[194:195], v[192:193] neg_lo:[1,0] neg_hi:[1,0]
    v_exp_f32 v188, v186
    v_exp_f32 v189, v187
    v_exp_f32 v196, v194
    v_exp_f32 v197, v195
    v_pk_mul_f32 v[190:191], v[184:185], v[166:167] op_sel_hi:[1,0]
    v_pk_add_f32 v[188:189], v[188:189], v[38:39] op_sel_hi:[1,0]
    v_pk_mul_f32 v[198:199], v[192:193], v[166:167] op_sel_hi:[1,0]
    v_pk_add_f32 v[196:197], v[196:197], v[38:39] op_sel_hi:[1,0]
    v_rcp_f32 v188, v188
    v_rcp_f32 v189, v189
    v_rcp_f32 v196, v196
    v_rcp_f32 v197, v197
    v_pk_fma_f32 v[180:181], v[190:191], v[188:189], v[180:181]
    v_pk_fma_f32 v[182:183], v[198:199], v[196:197], v[182:183]
    v_pk_fma_f32 v[184:185], v[32:33], s[40:41], v[34:35] op_sel_hi:[0,1,0]
    v_pk_fma_f32 v[192:193], v[32:33], s[42:43], v[34:35] op_sel_hi:[0,1,0]
    v_pk_fma_f32 v[186:187], v[184:185], v[184:185], v[250:251] op_sel_hi:[1,1,0]
    v_pk_fma_f32 v[194:195], v[192:193], v[192:193], v[250:251] op_sel_hi:[1,1,0]
    v_pk_mul_f32 v[186:187], v[186:187], v[184:185] neg_lo:[1,0] neg_hi:[1,0]
    v_pk_mul_f32 v[194:195], v[194:195], v[192:193] neg_lo:[1,0] neg_hi:[1,0]
    v_exp_f32 v188, v186
    v_exp_f32 v189, v187
    v_exp_f32 v196, v194
    v_exp_f32 v197, v195
    v_pk_mul_f32 v[190:191], v[184:185], v[36:37] op_sel_hi:[1,0]
    v_pk_add_f32 v[188:189], v[188:189], v[38:39] op_sel_hi:[1,0]
    v_pk_mul_f32 v[198:199], v[192:193], v[36:37] op_sel_hi:[1,0]
    v_pk_add_f32 v[196:197], v[196:197], v[38:39] op_sel_hi:[1,0]
    v_rcp_f32 v188, v188
    v_rcp_f32 v189, v189
    v_rcp_f32 v196, v196
    v_rcp_f32 v197, v197
    v_pk_fma_f32 v[168:169], v[190:191], v[188:189], v[168:169]
    v_pk_fma_f32 v[170:171], v[198:199], v[196:197], v[170:171]
    v_pk_fma_f32 v[184:185], v[32:33], s[44:45], v[34:35] op_sel_hi:[0,1,0]
    v_pk_fma_f32 v[192:193], v[32:33], s[46:47], v[34:35] op_sel_hi:[0,1,0]
    v_pk_fma_f32 v[186:187], v[184:185], v[184:185], v[250:251] op_sel_hi:[1,1,0]
    v_pk_fma_f32 v[194:195], v[192:193], v[192:193], v[250:251] op_sel_hi:[1,1,0]
    v_pk_mul_f32 v[186:187], v[186:187], v[184:185] neg_lo:[1,0] neg_hi:[1,0]
    v_pk_mul_f32 v[194:195], v[194:195], v[192:193] neg_lo:[1,0] neg_hi:[1,0]
    v_exp_f32 v188, v186
    v_exp_f32 v189, v187
    v_exp_f32 v196, v194
    v_exp_f32 v197, v195
    v_pk_mul_f32 v[190:191], v[184:185], v[36:37] op_sel_hi:[1,0]
    v_pk_add_f32 v[188:189], v[188:189], v[38:39] op_sel_hi:[1,0]
    v_pk_mul_f32 v[198:199], v[192:193], v[36:37] op_sel_hi:[1,0]
    v_pk_add_f32 v[196:197], v[196:197], v[38:39] op_sel_hi:[1,0]
    v_rcp_f32 v188, v188
    v_rcp_f32 v189, v189
    v_rcp_f32 v196, v196
    v_rcp_f32 v197, v197
    v_pk_fma_f32 v[172:173], v[190:191], v[188:189], v[172:173]
    v_pk_fma_f32 v[174:175], v[198:199], v[196:197], v[174:175]
    v_pk_fma_f32 v[184:185], v[32:33], s[48:49], v[34:35] op_sel_hi:[0,1,0]
    v_pk_fma_f32 v[192:193], v[32:33], s[50:51], v[34:35] op_sel_hi:[0,1,0]
    v_pk_fma_f32 v[186:187], v[184:185], v[184:185], v[250:251] op_sel_hi:[1,1,0]
    v_pk_fma_f32 v[194:195], v[192:193], v[192:193], v[250:251] op_sel_hi:[1,1,0]
    v_pk_mul_f32 v[186:187], v[186:187], v[184:185] neg_lo:[1,0] neg_hi:[1,0]
    v_pk_mul_f32 v[194:195], v[194:195], v[192:193] neg_lo:[1,0] neg_hi:[1,0]
    v_exp_f32 v188, v186
    v_exp_f32 v189, v187
    v_exp_f32 v196, v194
    v_exp_f32 v197, v195
    v_pk_mul_f32 v[190:191], v[184:185], v[36:37] op_sel_hi:[1,0]
    v_pk_add_f32 v[188:189], v[188:189], v[38:39] op_sel_hi:[1,0]
    v_pk_mul_f32 v[198:199], v[192:193], v[36:37] op_sel_hi:[1,0]
    v_pk_add_f32 v[196:197], v[196:197], v[38:39] op_sel_hi:[1,0]
    v_rcp_f32 v188, v188
    v_rcp_f32 v189, v189
    v_rcp_f32 v196, v196
    v_rcp_f32 v197, v197
    v_pk_fma_f32 v[176:177], v[190:191], v[188:189], v[176:177]
    v_pk_fma_f32 v[178:179], v[198:199], v[196:197], v[178:179]
    v_pk_fma_f32 v[184:185], v[32:33], s[52:53], v[34:35] op_sel_hi:[0,1,0]
    v_pk_fma_f32 v[192:193], v[32:33], s[54:55], v[34:35] op_sel_hi:[0,1,0]
    v_pk_fma_f32 v[186:187], v[184:185], v[184:185], v[250:251] op_sel_hi:[1,1,0]
    v_pk_fma_f32 v[194:195], v[192:193], v[192:193], v[250:251] op_sel_hi:[1,1,0]
    v_pk_mul_f32 v[186:187], v[186:187], v[184:185] neg_lo:[1,0] neg_hi:[1,0]
    v_pk_mul_f32 v[194:195], v[194:195], v[192:193] neg_lo:[1,0] neg_hi:[1,0]
    v_exp_f32 v188, v186
    v_exp_f32 v189, v187
    v_exp_f32 v196, v194
    v_exp_f32 v197, v195
    v_pk_mul_f32 v[190:191], v[184:185], v[36:37] op_sel_hi:[1,0]
    v_pk_add_f32 v[188:189], v[188:189], v[38:39] op_sel_hi:[1,0]
    v_pk_mul_f32 v[198:199], v[192:193], v[36:37] op_sel_hi:[1,0]
    v_pk_add_f32 v[196:197], v[196:197], v[38:39] op_sel_hi:[1,0]
    v_rcp_f32 v188, v188
    v_rcp_f32 v189, v189
    v_rcp_f32 v196, v196
    v_rcp_f32 v197, v197
    v_pk_fma_f32 v[180:181], v[190:191], v[188:189], v[180:181]
    v_pk_fma_f32 v[182:183], v[198:199], v[196:197], v[182:183]
    s_add_u32 s3, s3, 1
    s_cmp_lt_u32 s3, 9
    s_cbranch_scc1 Ltabloop
    v_permlane32_swap_b32 v168, v169
    v_permlane32_swap_b32 v170, v171
    v_permlane32_swap_b32 v172, v173
    v_permlane32_swap_b32 v174, v175
    v_permlane32_swap_b32 v176, v177
    v_permlane32_swap_b32 v178, v179
    v_permlane32_swap_b32 v180, v181
    v_permlane32_swap_b32 v182, v183
    v_add_f32 v168, v168, v169
    v_add_f32 v170, v170, v171
    v_add_f32 v172, v172, v173
    v_add_f32 v174, v174, v175
    v_add_f32 v176, v176, v177
    v_add_f32 v178, v178, v179
    v_add_f32 v180, v180, v181
    v_add_f32 v182, v182, v183
    v_permlane16_swap_b32 v168, v170
    v_permlane16_swap_b32 v172, v174
    v_permlane16_swap_b32 v176, v178
    v_permlane16_swap_b32 v180, v182
    v_add_f32 v168, v168, v170
    v_add_f32 v172, v172, v174
    v_add_f32 v176, v176, v178
    v_add_f32 v180, v180, v182
    v_add_f32_dpp v168, v168, v168 quad_perm:[1,0,3,2] row_mask:0xf bank_mask:0xf
    v_add_f32_dpp v172, v172, v172 quad_perm:[1,0,3,2] row_mask:0xf bank_mask:0xf
    v_add_f32_dpp v176, v176, v176 quad_perm:[1,0,3,2] row_mask:0xf bank_mask:0xf
    v_add_f32_dpp v180, v180, v180 quad_perm:[1,0,3,2] row_mask:0xf bank_mask:0xf
    v_add_f32_dpp v168, v168, v168 quad_perm:[2,3,0,1] row_mask:0xf bank_mask:0xf
    v_add_f32_dpp v172, v172, v172 quad_perm:[2,3,0,1] row_mask:0xf bank_mask:0xf
    v_add_f32_dpp v176, v176, v176 quad_perm:[2,3,0,1] row_mask:0xf bank_mask:0xf
    v_add_f32_dpp v180, v180, v180 quad_perm:[2,3,0,1] row_mask:0xf bank_mask:0xf
    v_add_f32_dpp v168, v168, v168 row_half_mirror row_mask:0xf bank_mask:0xf
    v_add_f32_dpp v172, v172, v172 row_half_mirror row_mask:0xf bank_mask:0xf
    v_add_f32_dpp v176, v176, v176 row_half_mirror row_mask:0xf bank_mask:0xf
    v_add_f32_dpp v180, v180, v180 row_half_mirror row_mask:0xf bank_mask:0xf
    v_add_f32_dpp v168, v168, v168 row_mirror row_mask:0xf bank_mask:0xf
    v_add_f32_dpp v172, v172, v172 row_mirror row_mask:0xf bank_mask:0xf
    v_add_f32_dpp v176, v176, v176 row_mirror row_mask:0xf bank_mask:0xf
    v_add_f32_dpp v180, v180, v180 row_mirror row_mask:0xf bank_mask:0xf
    v_lshrrev_b32 v251, 5, v1
    v_bfe_u32 v250, v1, 4, 1
    v_lshl_add_u32 v251, v250, 1, v251
    s_lshl_b32 s66, s30, 6
    s_add_u32 s66, s66, 58880
    v_lshl_add_u32 v251, v251, 2, s66
    s_mov_b32 exec_lo, 0x00010001
    s_mov_b32 exec_hi, 0x00010001
    ds_write2_b32 v251, v168, v172 offset0:0 offset1:4
    ds_write2_b32 v251, v176, v180 offset0:8 offset1:12
    s_mov_b64 exec, -1
    v_mov_b32 v252, 59656
    v_mov_b32 v253, 1
    s_mov_b64 exec, 1
    ds_add_u32 v252, v253
    s_mov_b64 exec, -1
    v_mov_b32 v252, 59660
Lsync_kv:
    ds_read_b32 v253, v252
    s_waitcnt lgkmcnt(0)
    v_readfirstlane_b32 s66, v253
    s_cmp_ge_u32 s66, 4
    s_cbranch_scc1 Lsync_kv_ok
    s_sub_u32 s38, s38, 1
    s_cbranch_scc0 Lsync_kv
    s_mov_b32 s38, 0
Lsync_kv_ok:
    s_cmp_lg_u32 s30, 7
    s_cbranch_scc1 Lnotab
    v_mov_b32 v252, 59656
Lsync_b:
    ds_read_b32 v253, v252
    s_waitcnt lgkmcnt(0)
    v_readfirstlane_b32 s66, v253
    s_cmp_ge_u32 s66, 4
    s_cbranch_scc1 Lsync_b_ok
    s_sub_u32 s38, s38, 1
    s_cbranch_scc0 Lsync_b
    s_mov_b32 s38, 0
Lsync_b_ok:
    v_and_b32 v250, 15, v1
    v_lshlrev_b32 v250, 2, v250
    v_add_u32 v251, 59136, v250
    ds_read2_b32 v[24:25], v251 offset0:0 offset1:16
    ds_read2_b32 v[26:27], v251 offset0:32 offset1:48
    s_waitcnt lgkmcnt(0)
    v_pk_add_f32 v[24:25], v[24:25], v[26:27]
    v_add_f32 v24, v24, v25
    v_mul_f32 v24, 0x40088e99, v24
    v_cvt_pk_bf16_f32 v24, v24, v24
    v_lshlrev_b32 v24, 16, v24
    v_add_f32 v24, v24, v97
    s_nop 1
    v_mov_b32_dpp v25, v24 quad_perm:[1,1,3,3] row_mask:0xf bank_mask:0xf
    v_cvt_pk_bf16_f32 v24, v24, v25
    v_lshrrev_b32 v250, 1, v250
    s_lshl_b32 s66, s2, 5
    s_add_u32 s66, s66, 655360
    v_add_u32 v250, s66, v250
    s_mov_b64 exec, 0x5555
    global_store_dword v250, v24, s[28:29] sc1
    s_mov_b64 exec, -1
Lnotab:
    v_bfe_u32 v249, v1, 2, 2
    v_mul_u32_u24 v249, 1088, v249
    v_and_b32 v250, 3, v1
    v_lshl_add_u32 v249, v250, 8, v249
    v_lshrrev_b32 v250, 4, v1
    v_lshl_add_u32 v249, v250, 4, v249
    v_mul_u32_u24 v250, 1088, v250
    v_and_b32 v251, 15, v1
    v_lshl_add_u32 v250, v251, 4, v250
    s_mul_i32 s67, s30, 8704
    s_add_u32 s68, s67, 34816
    v_add_u32 v249, s68, v249
    s_add_u32 s68, s67, 69632
    v_add_u32 v65, s68, v250
    ds_read_b128 v[32:35], v249 offset:0
    ds_read_b128 v[36:39], v249 offset:64
    ds_read_b128 v[40:43], v249 offset:128
    ds_read_b128 v[44:47], v249 offset:192
    ds_read_b128 v[48:51], v249 offset:4352
    ds_read_b128 v[52:55], v249 offset:4416
    ds_read_b128 v[56:59], v249 offset:4480
    ds_read_b128 v[60:63], v249 offset:4544
    s_call_b64 s[56:57], Lsel
    s_sub_u32 s67, s30, 4
    v_mov_b32 v252, 59672
Lsync_v:
    ds_read_b32 v253, v252
    s_waitcnt lgkmcnt(0)
    v_readfirstlane_b32 s66, v253
    s_bitcmp1_b32 s66, s67
    s_cbranch_scc1 Lsync_v_ok
    s_sub_u32 s38, s38, 1
    s_cbranch_scc0 Lsync_v
    s_mov_b32 s38, 0
Lsync_v_ok:
    ds_read_b128 v[200:203], v65 offset:0
    ds_read_b128 v[204:207], v65 offset:256
    ds_read_b128 v[208:211], v65 offset:512
    ds_read_b128 v[212:215], v65 offset:768
    ds_read_b128 v[216:219], v65 offset:4352
    ds_read_b128 v[220:223], v65 offset:4608
    ds_read_b128 v[224:227], v65 offset:4864
    ds_read_b128 v[228:231], v65 offset:5120
    s_waitcnt lgkmcnt(0)
    s_branch Lv_perm
Lv_back:
Lmeet:
    s_mov_b32 s48, s69
    s_mov_b32 s50, 0x00110011
    s_mov_b32 s51, 0x00110011
    s_mov_b32 s52, 0x00010001
    s_mov_b32 s53, 0x00010001
    s_mov_b32 s54, 0x01010101
    s_mov_b32 s55, 0x01010101
    s_mov_b64 s[20:21], s[64:65]
    s_and_b32 s66, s2, 7
    s_mul_i32 s66, s66, 6
    s_lshr_b32 s66, s66, 3
    s_mul_i32 s66, s66, 36864
    s_add_u32 s64, s20, s66
    s_addc_u32 s65, s21, 0
    s_sub_u32 s19, 221184, s66
    s_mov_b32 s22, -1
    s_mov_b32 s23, 0x3fffff
    s_add_u32 s4, s64, 4608
    s_addc_u32 s5, s65, 0
    s_add_u32 s6, s64, 9216
    s_addc_u32 s7, s65, 0
    s_add_u32 s8, s64, 13824
    s_addc_u32 s9, s65, 0
    s_mul_i32 s66, s34, 1280
    s_add_u32 s66, s66, 663552
    s_add_u32 s16, s28, s66
    s_addc_u32 s17, s29, 0
    v_mov_b32 v251, 59648
    s_waitcnt lgkmcnt(0)
    s_barrier
    ds_read_b32 v65, v251
Latt:
    s_mov_b64 exec, s[50:51]
    ds_read_b128 v[234:237], v2 offset:0
    ds_read_b128 v[238:241], v2 offset:64
    ds_read_b128 v[242:245], v2 offset:128
    ds_read_b128 v[246:249], v2 offset:192
    s_mov_b64 exec, -1
    s_waitcnt lgkmcnt(3)
    v_mfma_f32_16x16x32_bf16 v[24:27], v[32:35], v[234:237], 0
    v_mfma_f32_16x16x32_bf16 v[28:31], v[48:51], v[234:237], 0
    s_waitcnt lgkmcnt(2)
    v_mfma_f32_16x16x32_bf16 v[24:27], v[36:39], v[238:241], v[24:27]
    v_mfma_f32_16x16x32_bf16 v[28:31], v[52:55], v[238:241], v[28:31]
    s_waitcnt lgkmcnt(1)
    v_mfma_f32_16x16x32_bf16 v[24:27], v[40:43], v[242:245], v[24:27]
    v_mfma_f32_16x16x32_bf16 v[28:31], v[56:59], v[242:245], v[28:31]
    s_waitcnt lgkmcnt(0)
    v_mfma_f32_16x16x32_bf16 v[24:27], v[44:47], v[246:249], v[24:27]
    v_mfma_f32_16x16x32_bf16 v[28:31], v[60:63], v[246:249], v[28:31]
Lv_read_done:
    s_nop 6
    v_max3_f32 v255, v24, v25, v26
    v_max3_f32 v250, v27, v28, v29
    v_max3_f32 v255, v255, v30, v31
    v_max_f32 v251, v255, v250
    v_max_f32 v255, v255, v250
    s_nop 1
    v_permlane16_swap_b32 v255, v251
    v_max_f32 v250, v255, v251
    v_max_f32 v255, v255, v251
    s_nop 1
    v_permlane32_swap_b32 v255, v250
    v_max_f32 v255, v255, v250
    v_mul_f32 v250, s69, v255
    v_mul_f32 v255, s69, v255
    v_pk_fma_f32 v[24:25], v[24:25], s[48:49], v[250:251] op_sel_hi:[1,0,0] neg_lo:[0,0,1] neg_hi:[0,0,1]
    v_pk_fma_f32 v[26:27], v[26:27], s[48:49], v[250:251] op_sel_hi:[1,0,0] neg_lo:[0,0,1] neg_hi:[0,0,1]
    v_exp_f32 v24, v24
    v_exp_f32 v25, v25
    v_pk_fma_f32 v[28:29], v[28:29], s[48:49], v[250:251] op_sel_hi:[1,0,0] neg_lo:[0,0,1] neg_hi:[0,0,1]
    v_exp_f32 v26, v26
    v_exp_f32 v27, v27
    v_pk_fma_f32 v[30:31], v[30:31], s[48:49], v[250:251] op_sel_hi:[1,0,0] neg_lo:[0,0,1] neg_hi:[0,0,1]
    v_exp_f32 v28, v28
    v_exp_f32 v29, v29
    v_exp_f32 v30, v30
    v_exp_f32 v31, v31
    v_cvt_pk_bf16_f32 v250, v24, v25
    v_cvt_pk_bf16_f32 v251, v26, v27
    v_cvt_pk_bf16_f32 v252, v28, v29
    v_cvt_pk_bf16_f32 v253, v30, v31
    s_cmp_eq_u32 s35, 0
    s_cbranch_scc1 Lv_wait
Lv_ready:
    v_mfma_f32_16x16x32_bf16 v[64:67], v[250:253], v[100:103], 0
    v_mfma_f32_16x16x32_bf16 v[68:71], v[250:253], v[104:107], 0
    v_mfma_f32_16x16x32_bf16 v[72:75], v[250:253], v[108:111], 0
    v_mfma_f32_16x16x32_bf16 v[76:79], v[250:253], v[112:115], 0
    v_mfma_f32_16x16x32_bf16 v[80:83], v[250:253], v[116:119], 0
    v_mfma_f32_16x16x32_bf16 v[84:87], v[250:253], v[120:123], 0
    v_mfma_f32_16x16x32_bf16 v[88:91], v[250:253], v[124:127], 0
    v_mfma_f32_16x16x32_bf16 v[92:95], v[250:253], v[128:131], 0
    v_mfma_f32_16x16x32_bf16 v[24:27], v[250:253], v[200:203], 0
    s_mov_b32 exec_hi, 0
    ds_write2_b32 v12, v64, v68 offset0:0 offset1:16
    s_nop 0
    ds_write2_b32 v12, v72, v76 offset0:32 offset1:48
    s_nop 0
    ds_write2_b32 v12, v80, v84 offset0:64 offset1:80
    s_nop 0
    ds_write2_b32 v12, v88, v92 offset0:96 offset1:112
    s_mov_b32 exec_lo, 0x100001
    ds_write2_b32 v15, v255, v24 offset0:0 offset1:1
    s_mov_b64 exec, -1
    s_waitcnt lgkmcnt(0)
    s_barrier
    ds_read_b64 v[68:69], v14
    ds_read_b128 v[64:67], v13
    s_waitcnt lgkmcnt(1)
    v_max_f32_dpp v71, v68, v68 quad_perm:[1,0,3,2] row_mask:0xf bank_mask:0xf
    s_nop 1
    v_max_f32_dpp v71, v71, v71 quad_perm:[2,3,0,1] row_mask:0xf bank_mask:0xf
    s_nop 1
    v_max_f32_dpp v71, v71, v71 row_half_mirror row_mask:0xf bank_mask:0xf
    v_sub_f32 v70, v68, v71
    v_exp_f32 v70, v70
    v_mov_b32 v68, v71
    s_waitcnt lgkmcnt(0)
    v_mul_f32 v69, v69, v70
    v_pk_mul_f32 v[64:65], v[64:65], v[70:71] op_sel_hi:[1,0]
    v_pk_mul_f32 v[66:67], v[66:67], v[70:71] op_sel_hi:[1,0]
    v_add_f32_dpp v69, v69, v69 quad_perm:[1,0,3,2] row_mask:0xf bank_mask:0xf
    v_add_f32_dpp v64, v64, v64 quad_perm:[1,0,3,2] row_mask:0xf bank_mask:0xf
    v_add_f32_dpp v65, v65, v65 quad_perm:[1,0,3,2] row_mask:0xf bank_mask:0xf
    v_add_f32_dpp v66, v66, v66 quad_perm:[1,0,3,2] row_mask:0xf bank_mask:0xf
    v_add_f32_dpp v67, v67, v67 quad_perm:[1,0,3,2] row_mask:0xf bank_mask:0xf
    v_add_f32_dpp v69, v69, v69 quad_perm:[2,3,0,1] row_mask:0xf bank_mask:0xf
    v_add_f32_dpp v64, v64, v64 quad_perm:[2,3,0,1] row_mask:0xf bank_mask:0xf
    v_add_f32_dpp v65, v65, v65 quad_perm:[2,3,0,1] row_mask:0xf bank_mask:0xf
    v_add_f32_dpp v66, v66, v66 quad_perm:[2,3,0,1] row_mask:0xf bank_mask:0xf
    v_add_f32_dpp v67, v67, v67 quad_perm:[2,3,0,1] row_mask:0xf bank_mask:0xf
    v_add_f32_dpp v69, v69, v69 row_half_mirror row_mask:0xf bank_mask:0xf
    v_add_f32_dpp v64, v64, v64 row_half_mirror row_mask:0xf bank_mask:0xf
    v_add_f32_dpp v65, v65, v65 row_half_mirror row_mask:0xf bank_mask:0xf
    v_add_f32_dpp v66, v66, v66 row_half_mirror row_mask:0xf bank_mask:0xf
    v_add_f32_dpp v67, v67, v67 row_half_mirror row_mask:0xf bank_mask:0xf
    v_cvt_pk_bf16_f32 v67, v66, v67
    v_cvt_pk_bf16_f32 v66, v64, v65
    s_mov_b64 exec, s[54:55]
    s_cmp_eq_u32 s36, 0
    s_cbranch_scc1 Lsl1082
    global_store_dwordx4 v5, v[66:69], s[60:61]
    s_branch Lsd1082
Lsl1082:
    global_store_dwordx4 v5, v[66:69], s[60:61] sc1
Lsd1082:
    s_mov_b64 exec, -1
    s_cmp_eq_u32 s35, 0
    s_cbranch_scc1 Lstash
    s_waitcnt vmcnt(0)
Lopoll:
    global_load_dwordx4 v[74:77], v4, s[60:61] sc1
Lopoll_w:
    s_waitcnt vmcnt(0)
    v_max3_u32 v255, v74, v75, v76
    v_max_u32 v255, v255, v77
    v_cmp_eq_u32 vcc, -1, v255
    s_cbranch_vccnz Lopoll_again
Lopoll_ok:
    s_cmp_lg_u32 s35, 0
    s_cbranch_scc1 Lnotg
    global_load_dwordx4 v[234:237], v248, s[28:29] sc1
Lnotg:
    v_max_f32_dpp v79, v76, v76 quad_perm:[1,0,3,2] row_mask:0xf bank_mask:0xf
    v_lshlrev_b32 v80, 16, v74
    v_and_b32 v81, 0xffff0000, v74
    v_max_f32_dpp v79, v79, v79 quad_perm:[2,3,0,1] row_mask:0xf bank_mask:0xf
    v_lshlrev_b32 v82, 16, v75
    v_and_b32 v83, 0xffff0000, v75
    v_max_f32_dpp v79, v79, v79 row_half_mirror row_mask:0xf bank_mask:0xf
    v_sub_f32 v78, v76, v79
    v_exp_f32 v78, v78
    v_mov_b32 v76, v79
    v_mul_f32 v77, v77, v78
    v_pk_mul_f32 v[80:81], v[80:81], v[78:79] op_sel_hi:[1,0]
    v_pk_mul_f32 v[82:83], v[82:83], v[78:79] op_sel_hi:[1,0]
    v_add_f32_dpp v77, v77, v77 quad_perm:[1,0,3,2] row_mask:0xf bank_mask:0xf
    v_add_f32_dpp v80, v80, v80 quad_perm:[1,0,3,2] row_mask:0xf bank_mask:0xf
    v_add_f32_dpp v81, v81, v81 quad_perm:[1,0,3,2] row_mask:0xf bank_mask:0xf
    v_add_f32_dpp v82, v82, v82 quad_perm:[1,0,3,2] row_mask:0xf bank_mask:0xf
    v_add_f32_dpp v83, v83, v83 quad_perm:[1,0,3,2] row_mask:0xf bank_mask:0xf
    v_add_f32_dpp v77, v77, v77 quad_perm:[2,3,0,1] row_mask:0xf bank_mask:0xf
    v_add_f32_dpp v80, v80, v80 quad_perm:[2,3,0,1] row_mask:0xf bank_mask:0xf
    v_add_f32_dpp v81, v81, v81 quad_perm:[2,3,0,1] row_mask:0xf bank_mask:0xf
    v_add_f32_dpp v82, v82, v82 quad_perm:[2,3,0,1] row_mask:0xf bank_mask:0xf
    v_add_f32_dpp v83, v83, v83 quad_perm:[2,3,0,1] row_mask:0xf bank_mask:0xf
    v_add_f32_dpp v77, v77, v77 row_half_mirror row_mask:0xf bank_mask:0xf
    v_add_f32_dpp v80, v80, v80 row_half_mirror row_mask:0xf bank_mask:0xf
    v_add_f32_dpp v81, v81, v81 row_half_mirror row_mask:0xf bank_mask:0xf
    v_add_f32_dpp v82, v82, v82 row_half_mirror row_mask:0xf bank_mask:0xf
    v_add_f32_dpp v83, v83, v83 row_half_mirror row_mask:0xf bank_mask:0xf
    v_rcp_f32 v78, v77
    s_nop 0
    v_pk_mul_f32 v[80:81], v[80:81], v[78:79] op_sel_hi:[1,0]
    v_pk_mul_f32 v[82:83], v[82:83], v[78:79] op_sel_hi:[1,0]
    v_cvt_pk_bf16_f32 v64, v80, v81
    v_cvt_pk_bf16_f32 v65, v82, v83
    s_nop 0
    v_mov_b32_dpp v66, v64 row_ror:8 row_mask:0xf bank_mask:0xf
    v_mov_b32_dpp v67, v65 row_ror:8 row_mask:0xf bank_mask:0xf
    s_waitcnt lgkmcnt(0)
    s_nop 0
    v_mfma_f32_16x16x32_bf16 v[68:71], v[64:67], v[168:171], 0
    v_mfma_f32_16x16x32_bf16 v[72:75], v[64:67], v[172:175], 0
    v_mfma_f32_16x16x32_bf16 v[76:79], v[64:67], v[176:179], 0
    v_mfma_f32_16x16x32_bf16 v[80:83], v[64:67], v[180:183], 0
    v_mfma_f32_16x16x32_bf16 v[84:87], v[64:67], v[184:187], 0
    s_mov_b64 exec, 0xffff
    s_nop 3
    ds_write2_b32 v16, v68, v72 offset0:0 offset1:16
    s_nop 0
    ds_write2_b32 v16, v76, v80 offset0:32 offset1:48
    ds_write_b32 v16, v84 offset:256
    s_mov_b64 exec, -1
    s_waitcnt lgkmcnt(0)
    s_barrier
    s_cmp_lg_u32 s30, 0
    s_cbranch_scc1 Lwo_done
    s_mov_b64 exec, s[22:23]
    ds_read_b128 v[64:67], v17 offset:0
    ds_read_b128 v[68:71], v17 offset:320
    ds_read_b128 v[72:75], v17 offset:640
    ds_read_b128 v[76:79], v17 offset:960
    ds_read_b128 v[80:83], v17 offset:1280
    ds_read_b128 v[84:87], v17 offset:1600
    ds_read_b128 v[88:91], v17 offset:1920
    ds_read_b128 v[92:95], v17 offset:2240
    s_waitcnt lgkmcnt(6)
    v_pk_add_f32 v[64:65], v[64:65], v[68:69]
    v_pk_add_f32 v[66:67], v[66:67], v[70:71]
    s_waitcnt lgkmcnt(4)
    v_pk_add_f32 v[72:73], v[72:73], v[76:77]
    v_pk_add_f32 v[74:75], v[74:75], v[78:79]
    v_pk_add_f32 v[64:65], v[64:65], v[72:73]
    v_pk_add_f32 v[66:67], v[66:67], v[74:75]
    s_waitcnt lgkmcnt(2)
    v_pk_add_f32 v[80:81], v[80:81], v[84:85]
    v_pk_add_f32 v[82:83], v[82:83], v[86:87]
    s_waitcnt lgkmcnt(0)
    v_pk_add_f32 v[88:89], v[88:89], v[92:93]
    v_pk_add_f32 v[90:91], v[90:91], v[94:95]
    v_pk_add_f32 v[80:81], v[80:81], v[88:89]
    v_pk_add_f32 v[82:83], v[82:83], v[90:91]
    v_pk_add_f32 v[64:65], v[64:65], v[80:81]
    v_pk_add_f32 v[66:67], v[66:67], v[82:83]
    v_cvt_pk_bf16_f32 v64, v64, v65
    v_cvt_pk_bf16_f32 v65, v66, v67
    global_store_dwordx2 v11, v[64:65], s[20:21] sc1
    s_cmp_lg_u32 s35, 0
    s_cbranch_scc1 Lonecopy
    global_store_dwordx2 v6, v[64:65], s[20:21] sc1
Lonecopy:
    s_mov_b64 exec, -1
Lwo_done:
    s_cmp_eq_u32 s35, 0
    s_cbranch_scc1 Ltabg
    s_or_b32 s66, s31, s33
    s_cbranch_scc1 Lexit
    s_branch Lxwait
Ltpoll:
    global_load_dwordx4 v[234:237], v248, s[28:29] sc1
    s_waitcnt vmcnt(0)
Ltabg:
    s_cmp_gt_u32 s30, 3
    s_cselect_b32 s66, 61440, 0
    v_add_u32 v250, s66, v249
    s_waitcnt vmcnt(2)
    s_cmp_eq_u32 s30, 0
    s_cbranch_scc1 Ltabw
    s_waitcnt vmcnt(0)
Ltabw:
    v_max3_u32 v255, v234, v235, v236
    v_max_u32 v255, v255, v237
    v_cmp_eq_u32 vcc, -1, v255
    s_cbranch_vccz Ltpoll_ok
    s_sub_u32 s38, s38, 1
    s_cbranch_scc0 Ltpoll
    s_mov_b32 s38, 0
Ltpoll_ok:
    ds_write_b128 v250, v[234:237]
Lxwait:
    ds_read_b128 v[250:253], v18
    s_cmp_eq_u32 s30, 4
    s_cselect_b32 s68, 0x00ff00ff, -1
    s_mov_b32 exec_lo, s68
    s_mov_b32 exec_hi, s68
    s_cmp_gt_u32 s30, 4
    s_waitcnt vmcnt(0)
    s_barrier
    s_cbranch_scc1 Lxjoin
Lxpoll:
    global_load_dwordx4 v[64:67], v7, s[64:65] sc1
    global_load_dwordx4 v[68:71], v7, s[4:5] sc1
    global_load_dwordx4 v[72:75], v7, s[6:7] sc1
    global_load_dwordx4 v[76:79], v7, s[8:9] sc1
    s_mov_b64 exec, -1
    v_mov_b32 v30, 0
    v_mov_b32 v31, 0
    s_lshl_b32 s66, s30, 3
    s_add_u32 s66, s66, 59136
    v_mov_b32 v249, s66
Lxsum:
    s_waitcnt vmcnt(3)
    v_mfma_f32_16x16x32_bf16 v[24:27], v[196:199], v[64:67], 0
    s_waitcnt vmcnt(2)
    v_mfma_f32_16x16x32_bf16 v[24:27], v[196:199], v[68:71], v[24:27]
    s_waitcnt vmcnt(1)
    v_mfma_f32_16x16x32_bf16 v[24:27], v[196:199], v[72:75], v[24:27]
    s_waitcnt vmcnt(0)
    v_mfma_f32_16x16x32_bf16 v[24:27], v[196:199], v[76:79], v[24:27]
    s_mov_b32 exec_lo, s68
    s_mov_b32 exec_hi, 0
    s_waitcnt lgkmcnt(0)
    s_nop 4
    v_cmp_u_f32 vcc, v24, v24
    v_cvt_pk_bf16_f32 v28, v24, v25
    v_cvt_pk_bf16_f32 v29, v26, v27
    s_cbranch_vccnz Lxchk
Lxok:
    v_lshlrev_b32 v24, 16, v28
    v_and_b32 v25, 0xffff0000, v28
    v_lshlrev_b32 v26, 16, v29
    v_and_b32 v27, 0xffff0000, v29
    v_pk_add_f32 v[24:25], v[24:25], v[250:251]
    v_pk_add_f32 v[26:27], v[26:27], v[252:253]
    v_cvt_pk_bf16_f32 v28, v24, v25
    v_cvt_pk_bf16_f32 v29, v26, v27
    v_lshlrev_b32 v24, 16, v28
    v_and_b32 v25, 0xffff0000, v28
    v_lshlrev_b32 v26, 16, v29
    v_and_b32 v27, 0xffff0000, v29
    ds_write_b128 v18, v[24:27]
    v_pk_mul_f32 v[250:251], v[24:25], v[24:25]
    v_pk_add_f32 v[28:29], v[24:25], v[26:27]
    v_pk_fma_f32 v[250:251], v[26:27], v[26:27], v[250:251]
    v_add_f32 v30, v28, v29
    v_add_f32 v31, v250, v251
    s_mov_b32 exec_lo, -1
    v_add_f32_dpp v30, v30, v30 quad_perm:[1,0,3,2] row_mask:0xf bank_mask:0xf
    v_add_f32_dpp v31, v31, v31 quad_perm:[1,0,3,2] row_mask:0xf bank_mask:0xf
    s_nop 0
    v_add_f32_dpp v30, v30, v30 quad_perm:[2,3,0,1] row_mask:0xf bank_mask:0xf
    v_add_f32_dpp v31, v31, v31 quad_perm:[2,3,0,1] row_mask:0xf bank_mask:0xf
    s_nop 0
    v_add_f32_dpp v30, v30, v30 row_half_mirror row_mask:0xf bank_mask:0xf
    v_add_f32_dpp v31, v31, v31 row_half_mirror row_mask:0xf bank_mask:0xf
    s_nop 0
    v_add_f32_dpp v30, v30, v30 row_mirror row_mask:0xf bank_mask:0xf
    v_add_f32_dpp v31, v31, v31 row_mirror row_mask:0xf bank_mask:0xf
    s_nop 0
    v_add_f32_dpp v30, v30, v30 row_bcast:15 row_mask:0xa bank_mask:0xf
    v_add_f32_dpp v31, v31, v31 row_bcast:15 row_mask:0xa bank_mask:0xf
    s_mov_b32 exec_lo, 0x80000000
    ds_write_b64 v249, v[30:31]
    s_mov_b64 exec, -1
Lxjoin:
    s_lshl_b32 s66, s30, 9
    v_add_u32 v246, s66, v19
    v_mov_b32 v247, 59136
    s_waitcnt lgkmcnt(0)
    s_barrier
    s_cmp_gt_u32 s30, 3
    s_cbranch_scc1 Lmlp_skip
    ds_read_b128 v[234:237], v247
    ds_read_b128 v[238:241], v247 offset:16
    ds_read_b64 v[30:31], v247 offset:32
    ds_read_b32 v242, v20
    ds_read_b64 v[244:245], v246
    v_mov_b32 v74, 0
    v_mov_b32 v75, 0
    v_mov_b32 v76, 0
    s_lshl_b32 s66, s30, 8
    v_add_u32 v246, s66, v21
    v_lshl_add_u32 v247, v1, 2, s66
    v_lshlrev_b32 v248, 1, v1
    v_mov_b32 v249, 59676
    s_waitcnt lgkmcnt(3)
    v_pk_add_f32 v[234:235], v[234:235], v[236:237]
    v_pk_add_f32 v[238:239], v[238:239], v[240:241]
    s_waitcnt lgkmcnt(2)
    v_pk_add_f32 v[30:31], v[30:31], v[234:235]
    v_pk_add_f32 v[30:31], v[30:31], v[238:239]
    v_mul_f32 v24, v30, v254
    v_mul_f32 v26, v30, v8
    v_fma_f32 v25, v31, v8, v9
    v_fma_f32 v25, -v26, v24, v25
    v_max_f32 v25, v9, v25
    v_rsq_f32 v26, v25
    s_mov_b32 s66, 0x39003900
    s_waitcnt lgkmcnt(0)
    v_mul_f32 v28, v24, v26
    v_pk_fma_f32 v[64:65], v[244:245], v[26:27], v[28:29] op_sel_hi:[1,0,0] neg_lo:[0,0,1] neg_hi:[0,0,1]
    v_fma_f32 v66, v242, v26, -v28
    v_cvt_pk_bf16_f32 v90, v64, v65
    v_cvt_pk_bf16_f32 v91, v66, v66
    v_pk_sub_u16 v90, v90, s66
    v_pk_sub_u16 v91, v91, s66
    v_lshlrev_b32_sdwa v64, 1, v90 dst_sel:DWORD dst_unused:UNUSED_PAD src0_sel:DWORD src1_sel:WORD_0
    ds_read_u16_d16_hi v74, v64 offset:0
    v_lshlrev_b32_sdwa v65, 1, v90 dst_sel:DWORD dst_unused:UNUSED_PAD src0_sel:DWORD src1_sel:WORD_1
    ds_read_u16_d16_hi v75, v65 offset:0
    v_lshlrev_b32_sdwa v66, 1, v91 dst_sel:DWORD dst_unused:UNUSED_PAD src0_sel:DWORD src1_sel:WORD_0
    ds_read_u16_d16_hi v76, v66 offset:0
    v_or_b32 v255, v90, v91
    v_and_b32 v255, 0x78007800, v255
    v_cmp_ne_u32 vcc, 0, v255
    s_cmp_lg_u32 s35, 0
    s_waitcnt lgkmcnt(0)
    v_pk_add_f32 v[244:245], v[244:245], v[74:75]
    v_add_f32 v242, v242, v76
    s_cbranch_vccnz Lmiss
    v_cvt_pk_bf16_f32 v84, v244, v245
    v_cvt_pk_bf16_f32 v88, v242, v242
    s_cbranch_scc1 Lfin2
    ds_write_b32 v246, v84
    ds_write_b16 v22, v88
Lshare:
    s_waitcnt lgkmcnt(0)
    s_barrier
    ds_read_b32 v243, v249
    ds_read_b32 v84, v21 offset:0
    ds_read_b32 v85, v21 offset:256
    ds_read_b32 v86, v21 offset:512
    ds_read_b32 v87, v21 offset:768
    ds_read_u16 v88, v22
    s_mov_b64 exec, s[52:53]
    ds_read_b128 v[64:67], v23 offset:0
    ds_read_b128 v[68:71], v23 offset:64
    ds_read_b128 v[72:75], v23 offset:128
    ds_read_b128 v[76:79], v23 offset:192
    ds_read_b64 v[80:81], v96
    s_mov_b64 exec, -1
    s_waitcnt lgkmcnt(10)
    v_cmp_ne_u32 vcc, 0, v243
    s_cbranch_vccnz Lmlp
    s_add_u32 s58, s58, 65536
    s_addc_u32 s59, s59, 0
    s_waitcnt lgkmcnt(5)
    s_call_b64 s[56:57], Lq_unpack
    s_branch Lq_done
Lmiss:
    v_lshlrev_b32 v250, s35, 1
    ds_or_b32 v249, v250
    s_cbranch_scc0 Lshare
    s_branch Lfin3
Lfin2:
    global_store_dword v247, v84, s[24:25]
    s_cmp_lg_u32 s30, 0
    s_cbranch_scc1 Lfin3
    global_store_short v248, v88, s[24:25] offset:1024
Lfin3:
    s_waitcnt lgkmcnt(0)
    s_barrier
    ds_read_b32 v243, v249
    s_waitcnt lgkmcnt(0)
    v_cmp_lt_u32 vcc, 1, v243
    s_cbranch_vccz Lexit
Lmlp:
    s_waitcnt lgkmcnt(0)
    ds_read_b64 v[234:235], v19 offset:0
    ds_read_b64 v[236:237], v19 offset:512
    ds_read_b64 v[238:239], v19 offset:1024
    ds_read_b64 v[240:241], v19 offset:1536
    ds_read_b32 v242, v20
    v_mov_b32 v74, 0
    v_mov_b32 v75, 0
    v_mov_b32 v76, 0
    v_mov_b32 v77, 0
    v_mov_b32 v78, 0
    v_mov_b32 v79, 0
    v_mov_b32 v80, 0
    v_mov_b32 v81, 0
    v_mov_b32 v82, 0
    s_waitcnt lgkmcnt(0)
    v_pk_add_f32 v[24:25], v[234:235], v[236:237]
    v_pk_mul_f32 v[28:29], v[234:235], v[234:235]
    v_pk_add_f32 v[26:27], v[238:239], v[240:241]
    v_pk_fma_f32 v[28:29], v[236:237], v[236:237], v[28:29]
    v_pk_add_f32 v[24:25], v[24:25], v[26:27]
    v_pk_fma_f32 v[28:29], v[238:239], v[238:239], v[28:29]
    v_add_f32 v30, v24, v242
    v_pk_fma_f32 v[28:29], v[240:241], v[240:241], v[28:29]
    v_add_f32 v30, v30, v25
    v_fma_f32 v31, v242, v242, v28
    v_add_f32 v31, v31, v29
    v_add_f32_dpp v30, v30, v30 quad_perm:[1,0,3,2] row_mask:0xf bank_mask:0xf
    s_nop 0
    v_add_f32_dpp v31, v31, v31 quad_perm:[1,0,3,2] row_mask:0xf bank_mask:0xf
    v_add_f32_dpp v30, v30, v30 quad_perm:[2,3,0,1] row_mask:0xf bank_mask:0xf
    s_nop 0
    v_add_f32_dpp v31, v31, v31 quad_perm:[2,3,0,1] row_mask:0xf bank_mask:0xf
    v_add_f32_dpp v30, v30, v30 row_half_mirror row_mask:0xf bank_mask:0xf
    s_nop 0
    v_add_f32_dpp v31, v31, v31 row_half_mirror row_mask:0xf bank_mask:0xf
    v_add_f32_dpp v30, v30, v30 row_mirror row_mask:0xf bank_mask:0xf
    s_nop 0
    v_add_f32_dpp v31, v31, v31 row_mirror row_mask:0xf bank_mask:0xf
    v_add_f32_dpp v30, v30, v30 row_bcast:15 row_mask:0xa bank_mask:0xf
    s_nop 0
    v_add_f32_dpp v31, v31, v31 row_bcast:15 row_mask:0xa bank_mask:0xf
    v_add_f32_dpp v30, v30, v30 row_bcast:31 row_mask:0xc bank_mask:0xf
    s_nop 0
    v_add_f32_dpp v31, v31, v31 row_bcast:31 row_mask:0xc bank_mask:0xf
    v_readlane_b32 s66, v30, 63
    v_readlane_b32 s67, v31, 63
    s_nop 0
    v_mul_f32 v24, s66, v254
    v_mul_f32 v26, s66, v8
    v_fma_f32 v25, s67, v8, v9
    v_fma_f32 v25, -v26, v24, v25
    v_max_f32 v25, v9, v25
    v_rsq_f32 v26, v25
    s_nop 0
    v_mul_f32 v28, v24, v26
    v_pk_fma_f32 v[64:65], v[234:235], v[26:27], v[28:29] op_sel_hi:[1,0,0] neg_lo:[0,0,1] neg_hi:[0,0,1]
    v_pk_fma_f32 v[66:67], v[236:237], v[26:27], v[28:29] op_sel_hi:[1,0,0] neg_lo:[0,0,1] neg_hi:[0,0,1]
    v_pk_fma_f32 v[68:69], v[238:239], v[26:27], v[28:29] op_sel_hi:[1,0,0] neg_lo:[0,0,1] neg_hi:[0,0,1]
    v_pk_fma_f32 v[70:71], v[240:241], v[26:27], v[28:29] op_sel_hi:[1,0,0] neg_lo:[0,0,1] neg_hi:[0,0,1]
    v_fma_f32 v72, v242, v26, -v28
    s_mov_b32 s66, 0x39003900
    v_cvt_pk_bf16_f32 v84, v64, v65
    v_cvt_pk_bf16_f32 v85, v66, v67
    v_cvt_pk_bf16_f32 v86, v68, v69
    v_cvt_pk_bf16_f32 v87, v70, v71
    v_cvt_pk_bf16_f32 v88, v72, v72
    v_pk_sub_u16 v90, v84, s66
    v_pk_sub_u16 v91, v85, s66
    v_pk_sub_u16 v92, v86, s66
    v_pk_sub_u16 v93, v87, s66
    v_pk_sub_u16 v94, v88, s66
    v_lshlrev_b32_sdwa v64, 1, v90 dst_sel:DWORD dst_unused:UNUSED_PAD src0_sel:DWORD src1_sel:WORD_0
    ds_read_u16_d16_hi v74, v64 offset:0
    v_lshlrev_b32_sdwa v65, 1, v90 dst_sel:DWORD dst_unused:UNUSED_PAD src0_sel:DWORD src1_sel:WORD_1
    ds_read_u16_d16_hi v75, v65 offset:0
    v_lshlrev_b32_sdwa v66, 1, v91 dst_sel:DWORD dst_unused:UNUSED_PAD src0_sel:DWORD src1_sel:WORD_0
    ds_read_u16_d16_hi v76, v66 offset:0
    v_lshlrev_b32_sdwa v67, 1, v91 dst_sel:DWORD dst_unused:UNUSED_PAD src0_sel:DWORD src1_sel:WORD_1
    ds_read_u16_d16_hi v77, v67 offset:0
    v_lshlrev_b32_sdwa v68, 1, v92 dst_sel:DWORD dst_unused:UNUSED_PAD src0_sel:DWORD src1_sel:WORD_0
    ds_read_u16_d16_hi v78, v68 offset:0
    v_lshlrev_b32_sdwa v69, 1, v92 dst_sel:DWORD dst_unused:UNUSED_PAD src0_sel:DWORD src1_sel:WORD_1
    ds_read_u16_d16_hi v79, v69 offset:0
    v_lshlrev_b32_sdwa v70, 1, v93 dst_sel:DWORD dst_unused:UNUSED_PAD src0_sel:DWORD src1_sel:WORD_0
    ds_read_u16_d16_hi v80, v70 offset:0
    v_lshlrev_b32_sdwa v71, 1, v93 dst_sel:DWORD dst_unused:UNUSED_PAD src0_sel:DWORD src1_sel:WORD_1
    ds_read_u16_d16_hi v81, v71 offset:0
    v_lshlrev_b32_sdwa v72, 1, v94 dst_sel:DWORD dst_unused:UNUSED_PAD src0_sel:DWORD src1_sel:WORD_0
    ds_read_u16_d16_hi v82, v72 offset:0
    v_or3_b32 v255, v90, v91, v92
    v_or3_b32 v255, v255, v93, v94
    v_and_b32 v255, 0x78007800, v255
    v_cmp_ne_u32 vcc, 0, v255
    s_waitcnt lgkmcnt(0)
    s_cbranch_vccnz Lfallback
Lfb_done:
    v_pk_add_f32 v[234:235], v[234:235], v[74:75]
    v_pk_add_f32 v[236:237], v[236:237], v[76:77]
    v_pk_add_f32 v[238:239], v[238:239], v[78:79]
    v_pk_add_f32 v[240:241], v[240:241], v[80:81]
    v_add_f32 v242, v242, v82
    v_cvt_pk_bf16_f32 v84, v234, v235
    v_cvt_pk_bf16_f32 v85, v236, v237
    v_cvt_pk_bf16_f32 v86, v238, v239
    v_cvt_pk_bf16_f32 v87, v240, v241
    v_cvt_pk_bf16_f32 v88, v242, v242
    s_cmp_lg_u32 s35, 0
    s_cbranch_scc1 Lfinal
    s_add_u32 s58, s58, 65536
    s_addc_u32 s59, s59, 0
    s_call_b64 s[56:57], Lqstage
Lq_done:
    s_cmp_lg_u32 s30, 0
    s_cbranch_scc1 Lnext
    ds_write_b64 v19, v[234:235] offset:2304
    ds_write_b64 v19, v[236:237] offset:2816
    ds_write_b64 v19, v[238:239] offset:3328
    ds_write_b64 v19, v[240:241] offset:3840
    ds_write_b32 v20, v242 offset:2304
    s_branch Lnext
Lmlp_skip:
    s_cmp_lg_u32 s35, 0
    s_cbranch_scc1 Lexit
    s_barrier
Lqwait:
    s_add_u32 s58, s58, 65536
    s_addc_u32 s59, s59, 0
    s_lshr_b32 s66, s30, 1
    s_cmp_lg_u32 s66, 2
    s_cbranch_scc1 Lnext
Lqpoll:
    global_load_dwordx4 v[234:237], v98, s[58:59] sc1
    s_waitcnt vmcnt(0)
    v_max3_u32 v255, v234, v235, v236
    v_max_u32 v255, v255, v237
    v_cmp_eq_u32 vcc, -1, v255
    s_cbranch_vccnz Lqpoll_again
Lqpoll_ok:
    v_mfma_f32_16x16x32_bf16 v[24:27], v[196:199], v[234:237], 0
    s_nop 7
    v_cvt_pk_bf16_f32 v234, v24, v25
    v_cvt_pk_bf16_f32 v235, v26, v27
    s_mov_b32 exec_hi, 0
    ds_write_b64 v99, v[234:235]
    s_mov_b32 exec_hi, -1
Lnext:
    s_add_u32 s60, s60, 262144
    s_addc_u32 s61, s61, 0
    s_add_u32 s64, s64, s19
    s_addc_u32 s65, s65, 0
    s_add_u32 s4, s4, s19
    s_addc_u32 s5, s5, 0
    s_add_u32 s6, s6, s19
    s_addc_u32 s7, s7, 0
    s_add_u32 s8, s8, s19
    s_addc_u32 s9, s9, 0
    s_mov_b64 s[20:21], s[64:65]
    s_mov_b64 s[22:23], 0x3ffff
    v_add_u32 v18, 2304, v18
    v_add_u32 v19, 2304, v19
    v_add_u32 v20, 2304, v20
    s_mov_b32 s35, 1
    s_waitcnt lgkmcnt(0)
    s_barrier
    s_branch Latt
Lopoll_again:
    s_sub_u32 s38, s38, 1
    s_cbranch_scc0 Lopoll
    s_mov_b32 s38, 0
    s_branch Lopoll_ok
Lqpoll_again:
    s_sub_u32 s38, s38, 1
    s_cbranch_scc0 Lqpoll
    s_mov_b32 s38, 0
    s_branch Lqpoll_ok
Lv_wait:
    v_readfirstlane_b32 s36, v65
    v_lshlrev_b32 v249, 4, v0
    s_and_b32 s66, s2, 0
    s_lshl_b32 s66, s66, 13
    s_add_u32 s66, s66, 655360
    v_add_u32 v248, s66, v249
    s_cmp_gt_u32 s30, 3
    s_cbranch_scc1 Lv_tab
    s_sub_u32 s66, s30, 1
    s_cmp_lt_u32 s66, 3
    s_cbranch_scc1 Lv_wo
    s_waitcnt vmcnt(0) lgkmcnt(0)
    s_branch Lv_perm
Lv_wo:
    s_mul_i32 s67, s30, 768
    s_mov_b32 exec_hi, 0xffff
    s_add_u32 m0, s67, 26368
    s_add_u32 s12, s12, 1152
    s_addc_u32 s13, s13, 0
    global_load_lds_dwordx4 v232, s[12:13] nt
    s_add_u32 m0, s67, 28672
    s_add_u32 s12, s12, 1152
    s_addc_u32 s13, s13, 0
    global_load_lds_dwordx4 v232, s[12:13] nt
    s_add_u32 m0, s67, 30976
    s_add_u32 s12, s12, 1152
    s_addc_u32 s13, s13, 0
    global_load_lds_dwordx4 v232, s[12:13] nt
    s_add_u32 m0, s67, 33280
    s_add_u32 s12, s12, 1152
    s_addc_u32 s13, s13, 0
    global_load_lds_dwordx4 v232, s[12:13] nt
    s_add_u32 m0, s67, 35584
    s_add_u32 s12, s12, 1152
    s_addc_u32 s13, s13, 0
    global_load_lds_dwordx4 v232, s[12:13] nt
    s_add_u32 m0, s67, 37888
    s_add_u32 s12, s12, 1152
    s_addc_u32 s13, s13, 0
    global_load_lds_dwordx4 v232, s[12:13] nt
    s_mov_b32 exec_hi, -1
    s_waitcnt vmcnt(16)
Lv_perm:
    s_mov_b32 s66, 0x05040100
    s_mov_b32 s67, 0x07060302
    v_perm_b32 v100, v204, v200, s66
    v_perm_b32 v101, v212, v208, s66
    v_perm_b32 v102, v220, v216, s66
    v_perm_b32 v103, v228, v224, s66
    v_perm_b32 v104, v204, v200, s67
    v_perm_b32 v105, v212, v208, s67
    v_perm_b32 v106, v220, v216, s67
    v_perm_b32 v107, v228, v224, s67
    v_perm_b32 v108, v205, v201, s66
    v_perm_b32 v109, v213, v209, s66
    v_perm_b32 v110, v221, v217, s66
    v_perm_b32 v111, v229, v225, s66
    v_perm_b32 v112, v205, v201, s67
    v_perm_b32 v113, v213, v209, s67
    v_perm_b32 v114, v221, v217, s67
    v_perm_b32 v115, v229, v225, s67
    v_perm_b32 v116, v206, v202, s66
    v_perm_b32 v117, v214, v210, s66
    v_perm_b32 v118, v222, v218, s66
    v_perm_b32 v119, v230, v226, s66
    v_perm_b32 v120, v206, v202, s67
    v_perm_b32 v121, v214, v210, s67
    v_perm_b32 v122, v222, v218, s67
    v_perm_b32 v123, v230, v226, s67
    v_perm_b32 v124, v207, v203, s66
    v_perm_b32 v125, v215, v211, s66
    v_perm_b32 v126, v223, v219, s66
    v_perm_b32 v127, v231, v227, s66
    v_perm_b32 v128, v207, v203, s67
    v_perm_b32 v129, v215, v211, s67
    v_perm_b32 v130, v223, v219, s67
    v_perm_b32 v131, v231, v227, s67
    v_mov_b32 v200, 0x3f803f80
    v_mov_b32 v201, 0x3f803f80
    v_mov_b32 v202, 0x3f803f80
    v_mov_b32 v203, 0x3f803f80
    s_cmp_gt_u32 s30, 3
    s_cbranch_scc1 Lv_back
Lv_tab:
    s_branch Lv_ready
Lstash:
    s_cmp_lt_u32 s30, 4
    s_cbranch_scc1 Lstashed
    s_mul_i32 s67, s30, 8704
    s_add_u32 s67, s67, 34816
    v_lshl_add_u32 v250, v1, 4, s67
    v_lshl_add_u32 v251, v1, 2, s67
    ds_write_b128 v250, v[132:135] offset:0
    ds_write_b128 v250, v[136:139] offset:1024
    ds_write_b32 v251, v140 offset:2048
    ds_write_b128 v250, v[142:145] offset:2304
    ds_write_b128 v250, v[146:149] offset:3328
    ds_write_b32 v251, v150 offset:4352
    ds_write_b128 v250, v[152:155] offset:4608
    ds_write_b128 v250, v[156:159] offset:5632
    ds_write_b32 v251, v160 offset:6656
Lstashed:
    s_waitcnt vmcnt(0)
    global_load_dwordx4 v[74:77], v4, s[60:61] sc1
    s_barrier
    ds_read_b64_tr_b16 v[168:169], v233 offset:0
    ds_read_b64_tr_b16 v[170:171], v233 offset:576
    ds_read_b64_tr_b16 v[172:173], v233 offset:32
    ds_read_b64_tr_b16 v[174:175], v233 offset:608
    ds_read_b64_tr_b16 v[176:177], v233 offset:64
    ds_read_b64_tr_b16 v[178:179], v233 offset:640
    ds_read_b64_tr_b16 v[180:181], v233 offset:96
    ds_read_b64_tr_b16 v[182:183], v233 offset:672
    ds_read_b64_tr_b16 v[184:185], v233 offset:128
    ds_read_b64_tr_b16 v[186:187], v233 offset:704
    s_branch Lopoll_w
Lxchk:
    s_mov_b32 exec_hi, s68
    v_max3_u32 v255, v64, v65, v66
    v_max3_u32 v255, v255, v67, v68
    v_max3_u32 v255, v255, v69, v70
    v_max3_u32 v255, v255, v71, v72
    v_max3_u32 v255, v255, v73, v74
    v_max3_u32 v255, v255, v75, v76
    v_max3_u32 v255, v255, v77, v78
    v_max_u32 v255, v255, v79
    v_cmp_eq_u32 vcc, -1, v255
    s_sub_u32 s38, s38, 1
    s_cbranch_vccz Lxdone
    s_cbranch_scc0 Lxpoll
Lxdone:
    s_mov_b32 exec_hi, 0
    s_cbranch_scc0 Lxok
    s_mov_b32 s38, 0
    s_branch Lxok
Lfinal:
    s_cmp_lg_u32 s30, 0
    s_cbranch_scc1 Lexit
    v_lshlrev_b32 v249, 2, v1
    v_lshlrev_b32 v250, 1, v1
    global_store_dword v249, v84, s[24:25] offset:0
    global_store_dword v249, v85, s[24:25] offset:256
    global_store_dword v249, v86, s[24:25] offset:512
    global_store_dword v249, v87, s[24:25] offset:768
    global_store_short v250, v88, s[24:25] offset:1024
Lexit:
Lend:
    s_endpgm
Lqstage:
    ds_write_b32 v21, v84 offset:0
    ds_write_b32 v21, v85 offset:256
    ds_write_b32 v21, v86 offset:512
    ds_write_b32 v21, v87 offset:768
    ds_write_b16 v22, v88
    ds_read_b128 v[64:67], v23 offset:0
    ds_read_b128 v[68:71], v23 offset:64
    ds_read_b128 v[72:75], v23 offset:128
    ds_read_b128 v[76:79], v23 offset:192
    ds_read_b64 v[80:81], v96
Lq_unpack:
    v_lshlrev_b32 v234, 16, v84
    v_and_b32 v235, 0xffff0000, v84
    v_lshlrev_b32 v236, 16, v85
    v_and_b32 v237, 0xffff0000, v85
    v_lshlrev_b32 v238, 16, v86
    v_and_b32 v239, 0xffff0000, v86
    v_lshlrev_b32 v240, 16, v87
    v_and_b32 v241, 0xffff0000, v87
    v_lshlrev_b32 v242, 16, v88
    v_pk_add_f32 v[24:25], v[234:235], v[236:237]
    v_pk_mul_f32 v[28:29], v[234:235], v[234:235]
    v_pk_add_f32 v[26:27], v[238:239], v[240:241]
    v_pk_fma_f32 v[28:29], v[236:237], v[236:237], v[28:29]
    v_pk_add_f32 v[24:25], v[24:25], v[26:27]
    v_pk_fma_f32 v[28:29], v[238:239], v[238:239], v[28:29]
    v_add_f32 v30, v24, v242
    v_pk_fma_f32 v[28:29], v[240:241], v[240:241], v[28:29]
    v_add_f32 v30, v30, v25
    v_fma_f32 v31, v242, v242, v28
    v_add_f32 v31, v31, v29
    s_waitcnt lgkmcnt(4)
    v_mfma_f32_16x16x32_bf16 v[250:253], v[132:135], v[64:67], 0
    v_add_f32_dpp v30, v30, v30 quad_perm:[1,0,3,2] row_mask:0xf bank_mask:0xf
    v_add_f32_dpp v31, v31, v31 quad_perm:[1,0,3,2] row_mask:0xf bank_mask:0xf
    v_mfma_f32_16x16x32_bf16 v[244:247], v[150:153], v[64:67], 0
    s_nop 0
    v_add_f32_dpp v30, v30, v30 quad_perm:[2,3,0,1] row_mask:0xf bank_mask:0xf
    v_add_f32_dpp v31, v31, v31 quad_perm:[2,3,0,1] row_mask:0xf bank_mask:0xf
    s_waitcnt lgkmcnt(3)
    v_mfma_f32_16x16x32_bf16 v[250:253], v[136:139], v[68:71], v[250:253]
    v_add_f32_dpp v30, v30, v30 row_half_mirror row_mask:0xf bank_mask:0xf
    v_add_f32_dpp v31, v31, v31 row_half_mirror row_mask:0xf bank_mask:0xf
    v_mfma_f32_16x16x32_bf16 v[244:247], v[154:157], v[68:71], v[244:247]
    s_nop 0
    v_add_f32_dpp v30, v30, v30 row_mirror row_mask:0xf bank_mask:0xf
    v_add_f32_dpp v31, v31, v31 row_mirror row_mask:0xf bank_mask:0xf
    s_waitcnt lgkmcnt(2)
    v_mfma_f32_16x16x32_bf16 v[250:253], v[140:143], v[72:75], v[250:253]
    v_add_f32_dpp v30, v30, v30 row_bcast:15 row_mask:0xa bank_mask:0xf
    v_add_f32_dpp v31, v31, v31 row_bcast:15 row_mask:0xa bank_mask:0xf
    v_mfma_f32_16x16x32_bf16 v[244:247], v[158:161], v[72:75], v[244:247]
    s_nop 0
    v_add_f32_dpp v30, v30, v30 row_bcast:31 row_mask:0xc bank_mask:0xf
    v_add_f32_dpp v31, v31, v31 row_bcast:31 row_mask:0xc bank_mask:0xf
    s_waitcnt lgkmcnt(1)
    v_mfma_f32_16x16x32_bf16 v[250:253], v[144:147], v[76:79], v[250:253]
    v_readlane_b32 s66, v30, 63
    v_readlane_b32 s67, v31, 63
    v_mfma_f32_16x16x32_bf16 v[244:247], v[162:165], v[76:79], v[244:247]
    s_nop 0
    v_mul_f32 v24, s66, v254
    v_fma_f32 v25, s67, v254, v10
    s_waitcnt lgkmcnt(0)
    v_mfma_f32_16x16x16_bf16 v[250:253], v[148:149], v[80:81], v[250:253]
    v_fma_f32 v25, -v24, v24, v25
    v_max_f32 v25, v10, v25
    v_rsq_f32 v26, v25
    v_mfma_f32_16x16x16_bf16 v[244:247], v[166:167], v[80:81], v[244:247]
    s_nop 0
    v_mul_f32 v28, v24, v26
    v_pk_mul_f32 v[88:89], v[188:189], v[28:29] op_sel_hi:[1,0] neg_lo:[1,0] neg_hi:[1,0]
    v_pk_mul_f32 v[90:91], v[190:191], v[28:29] op_sel_hi:[1,0] neg_lo:[1,0] neg_hi:[1,0]
    v_pk_mul_f32 v[92:93], v[192:193], v[28:29] op_sel_hi:[1,0] neg_lo:[1,0] neg_hi:[1,0]
    v_pk_mul_f32 v[94:95], v[194:195], v[28:29] op_sel_hi:[1,0] neg_lo:[1,0] neg_hi:[1,0]
    v_pk_fma_f32 v[250:251], v[250:251], v[26:27], v[88:89] op_sel_hi:[1,0,1]
    v_pk_fma_f32 v[252:253], v[252:253], v[26:27], v[90:91] op_sel_hi:[1,0,1]
    v_cvt_pk_bf16_f32 v64, v250, v251
    v_cvt_pk_bf16_f32 v65, v252, v253
    v_pk_fma_f32 v[244:245], v[244:245], v[26:27], v[92:93] op_sel_hi:[1,0,1]
    v_pk_fma_f32 v[246:247], v[246:247], v[26:27], v[94:95] op_sel_hi:[1,0,1]
    v_cvt_pk_bf16_f32 v66, v244, v245
    v_cvt_pk_bf16_f32 v67, v246, v247
    s_mov_b64 exec, s[52:53]
    s_cmp_eq_u32 s36, 0
    s_cbranch_scc1 Lsl1787
    global_store_dwordx4 v3, v[64:67], s[58:59]
    s_branch Lsd1787
Lsl1787:
    global_store_dwordx4 v3, v[64:67], s[58:59] sc1
Lsd1787:
    s_mov_b64 exec, -1
    s_nop 0
    s_setpc_b64 s[56:57]
Lkshuf:
    v_mov_b32 v80, v32
    v_mov_b32 v81, v33
    v_mov_b32 v82, v34
    v_mov_b32 v83, v35
    v_mov_b32_dpp v32, v36 row_ror:8 row_mask:0xf bank_mask:0xc
    v_mov_b32_dpp v33, v37 row_ror:8 row_mask:0xf bank_mask:0xc
    v_mov_b32_dpp v34, v38 row_ror:8 row_mask:0xf bank_mask:0xc
    v_mov_b32_dpp v35, v39 row_ror:8 row_mask:0xf bank_mask:0xc
    v_mov_b32_dpp v36, v80 row_ror:8 row_mask:0xf bank_mask:0x3
    v_mov_b32_dpp v37, v81 row_ror:8 row_mask:0xf bank_mask:0x3
    v_mov_b32_dpp v38, v82 row_ror:8 row_mask:0xf bank_mask:0x3
    v_mov_b32_dpp v39, v83 row_ror:8 row_mask:0xf bank_mask:0x3
    v_mov_b32 v80, v40
    v_mov_b32 v81, v41
    v_mov_b32 v82, v42
    v_mov_b32 v83, v43
    v_mov_b32_dpp v40, v44 row_ror:8 row_mask:0xf bank_mask:0xc
    v_mov_b32_dpp v41, v45 row_ror:8 row_mask:0xf bank_mask:0xc
    v_mov_b32_dpp v42, v46 row_ror:8 row_mask:0xf bank_mask:0xc
    v_mov_b32_dpp v43, v47 row_ror:8 row_mask:0xf bank_mask:0xc
    v_mov_b32_dpp v44, v80 row_ror:8 row_mask:0xf bank_mask:0x3
    v_mov_b32_dpp v45, v81 row_ror:8 row_mask:0xf bank_mask:0x3
    v_mov_b32_dpp v46, v82 row_ror:8 row_mask:0xf bank_mask:0x3
    v_mov_b32_dpp v47, v83 row_ror:8 row_mask:0xf bank_mask:0x3
    v_mov_b32 v80, v48
    v_mov_b32 v81, v49
    v_mov_b32 v82, v50
    v_mov_b32 v83, v51
    v_mov_b32_dpp v48, v52 row_ror:8 row_mask:0xf bank_mask:0xc
    v_mov_b32_dpp v49, v53 row_ror:8 row_mask:0xf bank_mask:0xc
    v_mov_b32_dpp v50, v54 row_ror:8 row_mask:0xf bank_mask:0xc
    v_mov_b32_dpp v51, v55 row_ror:8 row_mask:0xf bank_mask:0xc
    v_mov_b32_dpp v52, v80 row_ror:8 row_mask:0xf bank_mask:0x3
    v_mov_b32_dpp v53, v81 row_ror:8 row_mask:0xf bank_mask:0x3
    v_mov_b32_dpp v54, v82 row_ror:8 row_mask:0xf bank_mask:0x3
    v_mov_b32_dpp v55, v83 row_ror:8 row_mask:0xf bank_mask:0x3
    v_mov_b32 v80, v56
    v_mov_b32 v81, v57
    v_mov_b32 v82, v58
    v_mov_b32 v83, v59
    v_mov_b32_dpp v56, v60 row_ror:8 row_mask:0xf bank_mask:0xc
    v_mov_b32_dpp v57, v61 row_ror:8 row_mask:0xf bank_mask:0xc
    v_mov_b32_dpp v58, v62 row_ror:8 row_mask:0xf bank_mask:0xc
    v_mov_b32_dpp v59, v63 row_ror:8 row_mask:0xf bank_mask:0xc
    v_mov_b32_dpp v60, v80 row_ror:8 row_mask:0xf bank_mask:0x3
    v_mov_b32_dpp v61, v81 row_ror:8 row_mask:0xf bank_mask:0x3
    v_mov_b32_dpp v62, v82 row_ror:8 row_mask:0xf bank_mask:0x3
    v_mov_b32_dpp v63, v83 row_ror:8 row_mask:0xf bank_mask:0x3
    s_setpc_b64 s[56:57]
Lsel:
    v_mov_b32 v27, 0x3f803f80
    v_and_b32 v24, 1, v1
    v_lshlrev_b32 v24, 4, v24
    v_lshlrev_b32 v24, v24, v27
    v_bfe_u32 v25, v1, 1, 3
    v_and_b32 v26, 1, v1
    v_cmp_eq_u32 vcc, 0, v26
    v_and_b32 v26, 0xffff, v24
    s_nop 0
    v_cndmask_b32 v24, v24, v26, vcc
    v_cmp_eq_u32 vcc, 0, v25
    s_nop 1
    v_cndmask_b32 v196, 0, v24, vcc
    v_cmp_eq_u32 vcc, 1, v25
    s_nop 1
    v_cndmask_b32 v197, 0, v24, vcc
    v_cmp_eq_u32 vcc, 2, v25
    s_nop 1
    v_cndmask_b32 v198, 0, v24, vcc
    v_cmp_eq_u32 vcc, 3, v25
    s_nop 1
    v_cndmask_b32 v199, 0, v24, vcc
    s_setpc_b64 s[56:57]
Laddr:
    v_mov_b32 v232, 0
    v_bfe_u32 v250, v24, 2, 1
    v_lshlrev_b32 v249, 8, v250
    v_lshl_add_u32 v249, v25, 4, v249
    v_add_u32 v2, 60416, v249
    s_and_b32 s66, s30, 1
    s_lshl_b32 s66, s66, 8
    v_lshl_add_u32 v249, v24, 4, s66
    v_lshl_add_u32 v98, v25, 9, v249
    v_and_b32 v250, 1, v25
    v_lshl_add_u32 v249, v250, 3, v249
    v_add_u32 v99, 60416, v249
    s_lshl_b32 s66, s33, 8
    s_lshl_b32 s67, s30, 6
    s_add_u32 s66, s66, s67
    v_lshl_add_u32 v3, v25, 4, s66
    s_lshl_b32 s66, s30, 7
    v_lshl_add_u32 v249, v27, 4, s66
    v_lshl_add_u32 v4, v26, 10, v249
    s_lshl_b32 s67, s33, 10
    v_add_u32 v5, s67, v249
    v_mul_u32_u24 v250, 1040, v26
    v_add_u32 v250, 40960, v250
    v_add_u32 v13, v249, v250
    s_mul_i32 s66, s30, 320
    s_add_u32 s66, s66, 60928
    v_lshl_add_u32 v16, v24, 2, s66
    s_lshr_b32 s66, s30, 2
    s_lshl_b32 s66, s66, 3
    v_lshl_add_u32 v6, v26, 4, s66
    v_add_u32 v14, 49280, v6
    s_lshl_b32 s66, s30, 8
    v_lshl_add_u32 v249, v24, 4, s66
    v_mul_u32_u24 v250, 1152, v25
    v_add_u32 v7, v249, v250
    v_and_b32 v253, 1, v25
    v_lshlrev_b32 v249, 1, v249
    v_lshl_add_u32 v249, v253, 4, v249
    v_add_u32 v18, 49920, v249
    s_mul_i32 s66, s31, 1152
    s_mul_i32 s67, s33, 144
    s_add_u32 s66, s66, s67
    v_mul_u32_u24 v250, 3641, v1
    v_lshrrev_b32 v250, 16, v250
    v_mul_u32_u24 v249, 18, v250
    v_sub_u32 v249, v1, v249
    v_lshlrev_b32 v17, 4, v249
    v_add_u32 v17, 60928, v17
    v_lshl_add_u32 v11, v249, 3, s66
    v_mul_u32_u24 v250, 36864, v250
    v_add_u32 v11, v250, v11
    v_add_u32 v6, 110592, v11
    s_mul_i32 s66, s30, 1040
    s_add_u32 s66, s66, 40960
    v_lshlrev_b32 v249, 9, v253
    v_lshl_add_u32 v249, v24, 2, v249
    v_add_u32 v12, s66, v249
    s_lshl_b32 s66, s30, 4
    s_add_u32 s66, s66, 49280
    v_lshl_add_u32 v15, v253, 3, s66
    v_lshlrev_b32 v249, 4, v25
    v_lshlrev_b32 v250, 3, v1
    v_add_u32 v19, 49920, v250
    v_add_u32 v20, 51968, v28
    s_mov_b32 s66, 54528
    v_add_u32 v21, s66, v28
    s_add_u32 s67, s66, 1024
    v_add_u32 v22, s67, v29
    s_mul_i32 s67, s39, 288
    s_add_u32 s66, s66, s67
    v_add_u32 v23, s66, v249
    s_add_u32 s66, s66, 256
    v_lshl_add_u32 v96, v25, 3, s66
    v_bfe_u32 v250, v1, 2, 2
    v_lshl_add_u32 v250, v25, 3, v250
    v_mul_u32_u24 v233, 144, v250
    v_and_b32 v250, 3, v1
    v_lshl_add_u32 v233, v250, 3, v233
    s_mul_i32 s66, s30, 4608
    s_add_u32 s66, s66, 4096
    v_add_u32 v233, s66, v233
    s_mov_b32 s10, 0
    v_mov_b32 v254, 0x3ae38e39
    v_mov_b32 v8, 0x3ae38ece
    v_mov_b32 v10, 0x3727c5ac
    v_mov_b32 v9, 0x2edbe6ff
    s_add_u32 s24, s24, s40
    s_addc_u32 s25, s25, 0
    s_mov_b32 s35, 0
    s_mov_b32 s36, 0
    s_mov_b32 s38, 1048576
    s_mov_b32 s69, 0x3e0293ee
    s_setpc_b64 s[56:57]
Lfallback:
    s_mul_i32 s67, s30, 8704
    s_add_u32 s67, s67, 69632
    v_lshl_add_u32 v250, v1, 4, s67
    v_lshl_add_u32 v251, v1, 2, s67
    ds_read_b128 v[204:207], v250 offset:0
    ds_read_b128 v[208:211], v250 offset:1024
    ds_read_b32 v212, v251 offset:2048
    ds_read_b128 v[214:217], v250 offset:2304
    ds_read_b128 v[218:221], v250 offset:3328
    ds_read_b32 v222, v251 offset:4352
    ds_read_b128 v[224:227], v250 offset:4608
    ds_read_b128 v[228:231], v250 offset:5632
    ds_read_b32 v232, v251 offset:6656
    v_bfe_u32 v255, v90, 11, 4
    v_cmp_ne_u32 s[14:15], 0, v255
    v_lshlrev_b32 v255, 16, v84
Lfb_l0:
    s_cmp_eq_u64 s[14:15], 0
    s_cbranch_scc1 Lfb_n0
    s_ff1_i32_b64 s3, s[14:15]
    s_bitset0_b64 s[14:15], s3
    v_readlane_b32 s12, v255, s3
    s_call_b64 s[56:57], Lfb_eval
    s_mov_b32 m0, s3
    v_writelane_b32 v74, s66, m0
    s_branch Lfb_l0
Lfb_n0:
    v_bfe_u32 v255, v90, 27, 4
    v_cmp_ne_u32 s[14:15], 0, v255
    v_and_b32 v255, 0xffff0000, v84
Lfb_l1:
    s_cmp_eq_u64 s[14:15], 0
    s_cbranch_scc1 Lfb_n1
    s_ff1_i32_b64 s3, s[14:15]
    s_bitset0_b64 s[14:15], s3
    v_readlane_b32 s12, v255, s3
    s_call_b64 s[56:57], Lfb_eval
    s_mov_b32 m0, s3
    v_writelane_b32 v75, s66, m0
    s_branch Lfb_l1
Lfb_n1:
    v_bfe_u32 v255, v91, 11, 4
    v_cmp_ne_u32 s[14:15], 0, v255
    v_lshlrev_b32 v255, 16, v85
Lfb_l2:
    s_cmp_eq_u64 s[14:15], 0
    s_cbranch_scc1 Lfb_n2
    s_ff1_i32_b64 s3, s[14:15]
    s_bitset0_b64 s[14:15], s3
    v_readlane_b32 s12, v255, s3
    s_call_b64 s[56:57], Lfb_eval
    s_mov_b32 m0, s3
    v_writelane_b32 v76, s66, m0
    s_branch Lfb_l2
Lfb_n2:
    v_bfe_u32 v255, v91, 27, 4
    v_cmp_ne_u32 s[14:15], 0, v255
    v_and_b32 v255, 0xffff0000, v85
Lfb_l3:
    s_cmp_eq_u64 s[14:15], 0
    s_cbranch_scc1 Lfb_n3
    s_ff1_i32_b64 s3, s[14:15]
    s_bitset0_b64 s[14:15], s3
    v_readlane_b32 s12, v255, s3
    s_call_b64 s[56:57], Lfb_eval
    s_mov_b32 m0, s3
    v_writelane_b32 v77, s66, m0
    s_branch Lfb_l3
Lfb_n3:
    v_bfe_u32 v255, v92, 11, 4
    v_cmp_ne_u32 s[14:15], 0, v255
    v_lshlrev_b32 v255, 16, v86
Lfb_l4:
    s_cmp_eq_u64 s[14:15], 0
    s_cbranch_scc1 Lfb_n4
    s_ff1_i32_b64 s3, s[14:15]
    s_bitset0_b64 s[14:15], s3
    v_readlane_b32 s12, v255, s3
    s_call_b64 s[56:57], Lfb_eval
    s_mov_b32 m0, s3
    v_writelane_b32 v78, s66, m0
    s_branch Lfb_l4
Lfb_n4:
    v_bfe_u32 v255, v92, 27, 4
    v_cmp_ne_u32 s[14:15], 0, v255
    v_and_b32 v255, 0xffff0000, v86
Lfb_l5:
    s_cmp_eq_u64 s[14:15], 0
    s_cbranch_scc1 Lfb_n5
    s_ff1_i32_b64 s3, s[14:15]
    s_bitset0_b64 s[14:15], s3
    v_readlane_b32 s12, v255, s3
    s_call_b64 s[56:57], Lfb_eval
    s_mov_b32 m0, s3
    v_writelane_b32 v79, s66, m0
    s_branch Lfb_l5
Lfb_n5:
    v_bfe_u32 v255, v93, 11, 4
    v_cmp_ne_u32 s[14:15], 0, v255
    v_lshlrev_b32 v255, 16, v87
Lfb_l6:
    s_cmp_eq_u64 s[14:15], 0
    s_cbranch_scc1 Lfb_n6
    s_ff1_i32_b64 s3, s[14:15]
    s_bitset0_b64 s[14:15], s3
    v_readlane_b32 s12, v255, s3
    s_call_b64 s[56:57], Lfb_eval
    s_mov_b32 m0, s3
    v_writelane_b32 v80, s66, m0
    s_branch Lfb_l6
Lfb_n6:
    v_bfe_u32 v255, v93, 27, 4
    v_cmp_ne_u32 s[14:15], 0, v255
    v_and_b32 v255, 0xffff0000, v87
Lfb_l7:
    s_cmp_eq_u64 s[14:15], 0
    s_cbranch_scc1 Lfb_n7
    s_ff1_i32_b64 s3, s[14:15]
    s_bitset0_b64 s[14:15], s3
    v_readlane_b32 s12, v255, s3
    s_call_b64 s[56:57], Lfb_eval
    s_mov_b32 m0, s3
    v_writelane_b32 v81, s66, m0
    s_branch Lfb_l7
Lfb_n7:
    v_bfe_u32 v255, v94, 11, 4
    v_cmp_ne_u32 s[14:15], 0, v255
    v_lshlrev_b32 v255, 16, v88
Lfb_l8:
    s_cmp_eq_u64 s[14:15], 0
    s_cbranch_scc1 Lfb_n8
    s_ff1_i32_b64 s3, s[14:15]
    s_bitset0_b64 s[14:15], s3
    v_readlane_b32 s12, v255, s3
    s_call_b64 s[56:57], Lfb_eval
    s_mov_b32 m0, s3
    v_writelane_b32 v82, s66, m0
    s_branch Lfb_l8
Lfb_n8:
    s_branch Lfb_done
Lfb_eval:
    v_mov_b32 v244, 0
    v_mov_b32 v245, 0
    v_mov_b32 v246, 0xbdd2d3e8
    v_mov_b32 v250, 0xc0135761
    v_mov_b32 v248, 1.0
    s_waitcnt lgkmcnt(0)
    v_lshlrev_b32 v64, 16, v204
    v_lshlrev_b32 v24, 16, v205
    v_and_b32 v65, 0xffff0000, v204
    v_and_b32 v25, 0xffff0000, v205
    v_lshlrev_b32 v66, 16, v214
    v_lshlrev_b32 v26, 16, v215
    v_and_b32 v67, 0xffff0000, v214
    v_and_b32 v27, 0xffff0000, v215
    v_lshlrev_b32 v68, 16, v224
    v_lshlrev_b32 v28, 16, v225
    v_and_b32 v69, 0xffff0000, v224
    v_and_b32 v29, 0xffff0000, v225
    v_pk_fma_f32 v[64:65], v[64:65], s[12:13], v[66:67] op_sel_hi:[1,0,1]
    v_pk_fma_f32 v[24:25], v[24:25], s[12:13], v[26:27] op_sel_hi:[1,0,1]
    v_pk_mul_f32 v[70:71], v[64:65], v[64:65]
    v_pk_mul_f32 v[30:31], v[24:25], v[24:25]
    v_pk_mul_f32 v[68:69], v[68:69], v[64:65]
    v_pk_mul_f32 v[28:29], v[28:29], v[24:25]
    v_pk_fma_f32 v[70:71], v[70:71], v[246:247], v[250:251] op_sel_hi:[1,0,0]
    v_pk_fma_f32 v[30:31], v[30:31], v[246:247], v[250:251] op_sel_hi:[1,0,0]
    v_pk_mul_f32 v[70:71], v[70:71], v[64:65]
    v_pk_mul_f32 v[30:31], v[30:31], v[24:25]
    v_exp_f32 v70, v70
    v_exp_f32 v30, v30
    v_exp_f32 v71, v71
    v_exp_f32 v31, v31
    v_pk_add_f32 v[70:71], v[70:71], v[248:249] op_sel_hi:[1,0]
    v_pk_add_f32 v[30:31], v[30:31], v[248:249] op_sel_hi:[1,0]
    v_rcp_f32 v70, v70
    v_rcp_f32 v30, v30
    v_rcp_f32 v71, v71
    v_rcp_f32 v31, v31
    v_pk_fma_f32 v[244:245], v[68:69], v[70:71], v[244:245]
    v_pk_fma_f32 v[244:245], v[28:29], v[30:31], v[244:245]
    v_lshlrev_b32 v64, 16, v206
    v_lshlrev_b32 v24, 16, v207
    v_and_b32 v65, 0xffff0000, v206
    v_and_b32 v25, 0xffff0000, v207
    v_lshlrev_b32 v66, 16, v216
    v_lshlrev_b32 v26, 16, v217
    v_and_b32 v67, 0xffff0000, v216
    v_and_b32 v27, 0xffff0000, v217
    v_lshlrev_b32 v68, 16, v226
    v_lshlrev_b32 v28, 16, v227
    v_and_b32 v69, 0xffff0000, v226
    v_and_b32 v29, 0xffff0000, v227
    v_pk_fma_f32 v[64:65], v[64:65], s[12:13], v[66:67] op_sel_hi:[1,0,1]
    v_pk_fma_f32 v[24:25], v[24:25], s[12:13], v[26:27] op_sel_hi:[1,0,1]
    v_pk_mul_f32 v[70:71], v[64:65], v[64:65]
    v_pk_mul_f32 v[30:31], v[24:25], v[24:25]
    v_pk_mul_f32 v[68:69], v[68:69], v[64:65]
    v_pk_mul_f32 v[28:29], v[28:29], v[24:25]
    v_pk_fma_f32 v[70:71], v[70:71], v[246:247], v[250:251] op_sel_hi:[1,0,0]
    v_pk_fma_f32 v[30:31], v[30:31], v[246:247], v[250:251] op_sel_hi:[1,0,0]
    v_pk_mul_f32 v[70:71], v[70:71], v[64:65]
    v_pk_mul_f32 v[30:31], v[30:31], v[24:25]
    v_exp_f32 v70, v70
    v_exp_f32 v30, v30
    v_exp_f32 v71, v71
    v_exp_f32 v31, v31
    v_pk_add_f32 v[70:71], v[70:71], v[248:249] op_sel_hi:[1,0]
    v_pk_add_f32 v[30:31], v[30:31], v[248:249] op_sel_hi:[1,0]
    v_rcp_f32 v70, v70
    v_rcp_f32 v30, v30
    v_rcp_f32 v71, v71
    v_rcp_f32 v31, v31
    v_pk_fma_f32 v[244:245], v[68:69], v[70:71], v[244:245]
    v_pk_fma_f32 v[244:245], v[28:29], v[30:31], v[244:245]
    v_lshlrev_b32 v64, 16, v208
    v_lshlrev_b32 v24, 16, v209
    v_and_b32 v65, 0xffff0000, v208
    v_and_b32 v25, 0xffff0000, v209
    v_lshlrev_b32 v66, 16, v218
    v_lshlrev_b32 v26, 16, v219
    v_and_b32 v67, 0xffff0000, v218
    v_and_b32 v27, 0xffff0000, v219
    v_lshlrev_b32 v68, 16, v228
    v_lshlrev_b32 v28, 16, v229
    v_and_b32 v69, 0xffff0000, v228
    v_and_b32 v29, 0xffff0000, v229
    v_pk_fma_f32 v[64:65], v[64:65], s[12:13], v[66:67] op_sel_hi:[1,0,1]
    v_pk_fma_f32 v[24:25], v[24:25], s[12:13], v[26:27] op_sel_hi:[1,0,1]
    v_pk_mul_f32 v[70:71], v[64:65], v[64:65]
    v_pk_mul_f32 v[30:31], v[24:25], v[24:25]
    v_pk_mul_f32 v[68:69], v[68:69], v[64:65]
    v_pk_mul_f32 v[28:29], v[28:29], v[24:25]
    v_pk_fma_f32 v[70:71], v[70:71], v[246:247], v[250:251] op_sel_hi:[1,0,0]
    v_pk_fma_f32 v[30:31], v[30:31], v[246:247], v[250:251] op_sel_hi:[1,0,0]
    v_pk_mul_f32 v[70:71], v[70:71], v[64:65]
    v_pk_mul_f32 v[30:31], v[30:31], v[24:25]
    v_exp_f32 v70, v70
    v_exp_f32 v30, v30
    v_exp_f32 v71, v71
    v_exp_f32 v31, v31
    v_pk_add_f32 v[70:71], v[70:71], v[248:249] op_sel_hi:[1,0]
    v_pk_add_f32 v[30:31], v[30:31], v[248:249] op_sel_hi:[1,0]
    v_rcp_f32 v70, v70
    v_rcp_f32 v30, v30
    v_rcp_f32 v71, v71
    v_rcp_f32 v31, v31
    v_pk_fma_f32 v[244:245], v[68:69], v[70:71], v[244:245]
    v_pk_fma_f32 v[244:245], v[28:29], v[30:31], v[244:245]
    v_lshlrev_b32 v64, 16, v210
    v_lshlrev_b32 v24, 16, v211
    v_and_b32 v65, 0xffff0000, v210
    v_and_b32 v25, 0xffff0000, v211
    v_lshlrev_b32 v66, 16, v220
    v_lshlrev_b32 v26, 16, v221
    v_and_b32 v67, 0xffff0000, v220
    v_and_b32 v27, 0xffff0000, v221
    v_lshlrev_b32 v68, 16, v230
    v_lshlrev_b32 v28, 16, v231
    v_and_b32 v69, 0xffff0000, v230
    v_and_b32 v29, 0xffff0000, v231
    v_pk_fma_f32 v[64:65], v[64:65], s[12:13], v[66:67] op_sel_hi:[1,0,1]
    v_pk_fma_f32 v[24:25], v[24:25], s[12:13], v[26:27] op_sel_hi:[1,0,1]
    v_pk_mul_f32 v[70:71], v[64:65], v[64:65]
    v_pk_mul_f32 v[30:31], v[24:25], v[24:25]
    v_pk_mul_f32 v[68:69], v[68:69], v[64:65]
    v_pk_mul_f32 v[28:29], v[28:29], v[24:25]
    v_pk_fma_f32 v[70:71], v[70:71], v[246:247], v[250:251] op_sel_hi:[1,0,0]
    v_pk_fma_f32 v[30:31], v[30:31], v[246:247], v[250:251] op_sel_hi:[1,0,0]
    v_pk_mul_f32 v[70:71], v[70:71], v[64:65]
    v_pk_mul_f32 v[30:31], v[30:31], v[24:25]
    v_exp_f32 v70, v70
    v_exp_f32 v30, v30
    v_exp_f32 v71, v71
    v_exp_f32 v31, v31
    v_pk_add_f32 v[70:71], v[70:71], v[248:249] op_sel_hi:[1,0]
    v_pk_add_f32 v[30:31], v[30:31], v[248:249] op_sel_hi:[1,0]
    v_rcp_f32 v70, v70
    v_rcp_f32 v30, v30
    v_rcp_f32 v71, v71
    v_rcp_f32 v31, v31
    v_pk_fma_f32 v[244:245], v[68:69], v[70:71], v[244:245]
    v_pk_fma_f32 v[244:245], v[28:29], v[30:31], v[244:245]
    v_lshlrev_b32 v64, 16, v212
    v_and_b32 v65, 0xffff0000, v212
    v_lshlrev_b32 v66, 16, v222
    v_and_b32 v67, 0xffff0000, v222
    v_lshlrev_b32 v68, 16, v232
    v_and_b32 v69, 0xffff0000, v232
    v_pk_fma_f32 v[64:65], v[64:65], s[12:13], v[66:67] op_sel_hi:[1,0,1]
    v_pk_mul_f32 v[70:71], v[64:65], v[64:65]
    v_pk_mul_f32 v[68:69], v[68:69], v[64:65]
    v_pk_fma_f32 v[70:71], v[70:71], v[246:247], v[250:251] op_sel_hi:[1,0,0]
    v_pk_mul_f32 v[70:71], v[70:71], v[64:65]
    v_exp_f32 v70, v70
    v_exp_f32 v71, v71
    s_nop 0
    v_pk_add_f32 v[70:71], v[70:71], v[248:249] op_sel_hi:[1,0]
    v_rcp_f32 v70, v70
    v_rcp_f32 v71, v71
    s_nop 0
    v_pk_fma_f32 v[244:245], v[68:69], v[70:71], v[244:245]
    v_add_f32 v244, v244, v245
    s_nop 1
    v_add_f32_dpp v244, v244, v244 quad_perm:[1,0,3,2] row_mask:0xf bank_mask:0xf
    s_nop 1
    v_add_f32_dpp v244, v244, v244 quad_perm:[2,3,0,1] row_mask:0xf bank_mask:0xf
    s_nop 1
    v_add_f32_dpp v244, v244, v244 row_half_mirror row_mask:0xf bank_mask:0xf
    s_nop 1
    v_add_f32_dpp v244, v244, v244 row_mirror row_mask:0xf bank_mask:0xf
    s_nop 1
    v_add_f32_dpp v244, v244, v244 row_bcast:15 row_mask:0xa bank_mask:0xf
    s_nop 1
    v_add_f32_dpp v244, v244, v244 row_bcast:31 row_mask:0xc bank_mask:0xf
    s_and_b32 s66, s10, 4
    s_lshl_b32 s66, s66, 2
    s_add_u32 s66, s66, 59680
    s_lshl_b32 s67, s30, 2
    s_add_u32 s67, s67, s66
    v_mov_b32 v249, s67
    v_mov_b32 v250, s66
    s_add_u32 s10, s10, 4
    s_mov_b32 exec_lo, 0
    s_mov_b32 exec_hi, 0x80000000
    ds_write_b32 v249, v244
    s_mov_b64 exec, -1
    v_mov_b32 v252, 59664
    v_mov_b32 v253, 1
    s_mov_b64 exec, 1
    ds_add_u32 v252, v253
    s_mov_b64 exec, -1
Lfb_spin:
    ds_read_b32 v253, v252
    s_waitcnt lgkmcnt(0)
    v_readfirstlane_b32 s66, v253
    s_cmp_ge_u32 s66, s10
    s_cbranch_scc1 Lfb_spin_ok
    s_sub_u32 s38, s38, 1
    s_cbranch_scc0 Lfb_spin
    s_mov_b32 s38, 0
Lfb_spin_ok:
    ds_read_b128 v[244:247], v250
    s_waitcnt lgkmcnt(0)
    v_pk_add_f32 v[244:245], v[244:245], v[246:247]
    v_add_f32 v244, v244, v245
    v_cvt_pk_bf16_f32 v244, v244, v244
    v_lshlrev_b32 v244, 16, v244
    v_add_f32 v244, v244, v97
    v_cvt_pk_bf16_f32 v244, v244, v244
    v_lshlrev_b32 v244, 16, v244
    s_nop 0
    v_readfirstlane_b32 s66, v244
    s_nop 3
    s_setpc_b64 s[56:57]
Lcode_end:
.section .rodata,"a"
.p2align 6
.amdhsa_kernel interleave_layers__sliding_block_cached__mixer_token_mlp__decode_kernel
  .amdhsa_next_free_vgpr 256
  .amdhsa_next_free_sgpr 102
  .amdhsa_accum_offset 256
  .amdhsa_group_segment_fixed_size 0
  .amdhsa_kernarg_size 104
  .amdhsa_user_sgpr_count 2
  .amdhsa_user_sgpr_kernarg_segment_ptr 1
  .amdhsa_system_sgpr_workgroup_id_x 1
.end_amdhsa_kernel
```
